```python
import torch

def _softmax(x, axis=-1):
    return torch.softmax(x, dim=axis)
def _gelu(x):
    return torch.nn.functional.gelu(x, approximate="tanh")
def _silu(x):
    return torch.nn.functional.silu(x)
def _sigmoid(x):
    return torch.sigmoid(x)
def _layernorm(x, axis=-1, eps=1e-5):
    m = x.mean(dim=axis, keepdim=True)
    v = x.var(dim=axis, keepdim=True, unbiased=False)
    return (x - m) / torch.sqrt(v + eps)
def _scatter_add(tgt, idx, src, axis=0):
    return tgt.clone().index_add_(axis, idx, src)
def _segment_sum(src, seg, n):
    out = torch.zeros((n,) + src.shape[1:], dtype=src.dtype)
    return out.index_add_(0, seg, src)
def _pad(x, pw):
    flat = tuple(v for pair in reversed(pw) for v in pair)
    return torch.nn.functional.pad(x, flat)

kernel_name = 'interleave_layers__sliding_local_dilated__ssm_conv_h3__prompt'

def setup_inputs():

    _w = (lambda a: (lambda t: t.to(torch.bfloat16) if t.is_floating_point() else t)(torch.as_tensor(a)))
    def _A_setup():
        B, S, D = 1, 2048, 576
        return {
            "x": _w((lambda *s: torch.randn(*s, dtype=torch.bfloat16) * 0.05)(B, S, D)),
            "wqkv": _w((lambda *s: torch.randn(*s, dtype=torch.bfloat16) * 0.05)(D, 3 * D)),
            "wo": _w((lambda *s: torch.randn(*s, dtype=torch.bfloat16) * 0.05)(D, D)),
        }
    _A_in = _A_setup()

    def _B_setup():
        B, S, D = 1, 2048, 576
        ks = 4
        return {
            "q": _w((lambda *s: torch.randn(*s, dtype=torch.bfloat16) * 0.05)(B, S, D)),
            "k": _w((lambda *s: torch.randn(*s, dtype=torch.bfloat16) * 0.4)(B, S, D)),
            "v": _w((lambda *s: torch.randn(*s, dtype=torch.bfloat16) * 0.4)(B, S, D)),
            "shift_k": _w((lambda *s: torch.randn(*s, dtype=torch.bfloat16) * 0.4)(D, ks) * 0.5),
            "ssm_k": _w((lambda *s: torch.randn(*s, dtype=torch.bfloat16) * 0.8)(D, S) * (1.0 / S ** 0.5)),
            "ssm_D": _w((lambda *s: torch.randn(*s, dtype=torch.bfloat16) * 0.4)(D)),
        }
    _B_in = _B_setup()

    return {
        "A_x": _A_in["x"],
        "A_wqkv": _A_in["wqkv"],
        "A_wo": _A_in["wo"],
        "B_q": _B_in["q"],
        "B_k": _B_in["k"],
        "B_v": _B_in["v"],
        "B_shift_k": _B_in["shift_k"],
        "B_ssm_k": _B_in["ssm_k"],
        "B_ssm_D": _B_in["ssm_D"],
    }

def reference(A_x, A_wqkv, A_wo, B_q, B_k, B_v, B_shift_k, B_ssm_k, B_ssm_D):
    def _A_ref(x, wqkv, wo):
        B, S, D = x.shape
        H = 32; Dh = D // H
        W, dil = 8, 2
        qkv = (lambda x, *d: x.permute(*d))((x @ wqkv).reshape(B, S, 3, H, Dh), 2, 0, 3, 1, 4)
        q, k, v = qkv[0], qkv[1], qkv[2]
        scale = Dh ** -0.5
        pos = torch.arange(S)
        off = torch.arange(W) * dil
        idx = pos[:, None] - off[None, :]
        mask = idx >= 0
        idx_c = torch.where(mask, idx, 0).reshape(-1)
        kg = k[:, :, idx_c, :].reshape(B, H, S, W, Dh)
        vg = v[:, :, idx_c, :].reshape(B, H, S, W, Dh)
        logits = torch.einsum("bhsd,bhswd->bhsw", q, kg) * scale
        logits = torch.where(mask[None, None, :, :], logits, -1e9)
        attn = _softmax(logits, axis=-1)
        o = torch.einsum("bhsw,bhswd->bhsd", attn, vg)
        return (lambda x, *d: x.permute(*d))(o, 0, 2, 1, 3).reshape(B, S, D) @ wo

    def _B_ref(q, k, v, shift_k, ssm_k, ssm_D):
        B, S, D = q.shape
        ks = shift_k.shape[-1]
        k_pad = _pad(k, ((0, 0), (ks - 1, 0), (0, 0)))
        k_shift = torch.zeros_like(k)
        for t in range(ks):
            k_shift = k_shift + k_pad[:, t:t + S, :] * shift_k[:, ks - 1 - t][None, None, :]
        kv = k_shift * v
        L = 2 * S
        kv_pad = _pad(kv, ((0, 0), (0, S), (0, 0)))
        kf_pad = _pad(ssm_k, ((0, 0), (0, S)))
        kv_f = (lambda x, axes=(-2,-1): torch.fft.rfft2(x.float(), dim=axes))(kv_pad[:, None, :, :], axes=(1, 2))
        kf_f = (lambda x, axes=(-2,-1): torch.fft.rfft2(x.float(), dim=axes))(kf_pad[:, None, :], axes=(1, 2))
        kf_f = (lambda x, *d: x.permute(*d))(kf_f, 1, 2, 0)
        y_f = kv_f * kf_f[None, :, :, :]
        y = (lambda x, s, axes=(-2,-1): torch.fft.irfft2(x, s=s, dim=axes).to(torch.bfloat16))(y_f, (1, L), axes=(1, 2))[:, 0, :S, :]
        y = y + kv * ssm_D[None, None, :]
        return q * y

    x = A_x
    x = x + _A_ref(_layernorm(x, axis=-1), A_wqkv, A_wo)
    x = x + _B_ref(_layernorm(x, axis=-1), B_k, B_v, B_shift_k, B_ssm_k, B_ssm_D)
    x = x + _A_ref(_layernorm(x, axis=-1), A_wqkv, A_wo)
    x = x + _B_ref(_layernorm(x, axis=-1), B_k, B_v, B_shift_k, B_ssm_k, B_ssm_D)
    return x
```

```asm
; @launch grid=(256,1,1) block=(512,1,1) lds=163840
.amdgcn_target "amdgcn-amd-amdhsa--gfx950"
.text
.globl interleave_layers__sliding_local_dilated__ssm_conv_h3__prompt_kernel
.p2align 8
.type interleave_layers__sliding_local_dilated__ssm_conv_h3__prompt_kernel,@function
interleave_layers__sliding_local_dilated__ssm_conv_h3__prompt_kernel:
    s_cmp_ge_u32 s2, 256
    s_cbranch_scc1 L5_end
    s_load_dwordx16 s[64:79], s[0:1], 0
    s_load_dwordx8 s[80:87], s[0:1], 64
    s_getpc_b64 s[92:93]
L5_pc:
    s_bfe_u32 s40, s2, 0x30003
    s_lshl_b32 s40, s40, 13
    v_lshlrev_b32 v4, 7, v0
    v_add_u32 v4, s40, v4
    v_min_u32 v4, L5_codeend-L5_pc, v4
    v_cmp_gt_u32 vcc, 64, v0
    s_nop 0
    s_mov_b64 exec, vcc
    global_load_dword a143, v4, s[92:93]
    s_mov_b64 exec, -1
    v_lshrrev_b32 v1, 6, v0
    v_and_b32 v2, 63, v0
    s_getreg_b32 s20, hwreg(HW_REG_XCC_ID, 0, 3)
    v_readfirstlane_b32 s3, v1
    s_lshr_b32 s21, s2, 3
    v_lshlrev_b32 v3, 4, v2
    s_mov_b32 s28, 200000
    s_mov_b32 s29, 0
    v_mov_b32 v1, 159744
    s_branch L5_restart
L5_fallback:
    s_mov_b32 s21, s41
    s_mov_b32 s29, 1
    s_mov_b32 s28, 200000
    s_waitcnt lgkmcnt(0)
    s_load_dwordx16 s[64:79], s[0:1], 0
    s_load_dwordx8 s[80:87], s[0:1], 64
    s_waitcnt vmcnt(0) lgkmcnt(0)
    s_barrier
L5_restart:
    s_and_b32 s22, s21, 15
    s_lshr_b32 s30, s21, 4
    s_lshl_b32 s23, s20, 1
    s_add_u32 s23, s23, s30
    s_and_b32 s24, s21, 7
    s_bfe_u32 s25, s21, 0x10003
    s_mul_i32 s26, s20, 393216
    s_add_u32 s26, s26, 11534336
    s_lshl_b32 s27, s20, 12
    s_add_u32 s27, s27, 19922944
    s_cmp_lg_u32 s3, 7
    s_cbranch_scc1 L5_nz
    v_mov_b32 v8, 0
    v_mov_b32 v9, 0
    v_lshl_add_u32 v12, v2, 3, v1
    v_lshl_add_u32 v13, v2, 2, v1
    ds_write_b64 v12, v[8:9]
    v_mov_b32 v14, 2
    s_mov_b64 exec, 0x1f
    ds_write_b32 v13, v14 offset:304
    s_mov_b64 exec, -1
L5_nz:
    s_waitcnt lgkmcnt(0)
    s_mov_b32 s4, s86
    s_mov_b32 s5, s87
    s_mov_b32 s6, 50331648
    s_mov_b32 s7, 0x00020000
    s_sub_u32 s31, s3, 4
    s_cmp_eq_u32 s3, 7
    s_cbranch_scc1 L5_w7
    s_mov_b32 s16, s76
    s_mov_b32 s17, s77
    s_mov_b32 s18, 4608
    s_mov_b32 s19, 0x00020000
    s_mov_b32 s34, s3
    s_mul_i32 s40, s3, 4
    s_lshr_b32 s35, 0xff078ff, s40
    s_and_b32 s35, s35, 15
    s_cmp_eq_u32 s35, 15
    s_cselect_b32 s41, s3, s35
    s_cselect_b32 s35, -1, s35
    v_and_b32 v4, 7, v2
    v_lshlrev_b32 v4, 3, v4
    s_mul_i32 s40, s20, 576
    s_lshl_b32 s42, s3, 6
    s_lshl_b32 s41, s41, 6
    s_add_u32 s41, s41, s40
    s_add_u32 s40, s40, s42
    buffer_load_dwordx2 v[104:105], v4, s[16:19], s40 offen
    buffer_load_dwordx2 v[106:107], v4, s[16:19], s41 offen
    s_cmp_ge_u32 s3, 4
    s_cbranch_scc1 L5_a
    s_cmp_eq_u32 s3, 3
    s_cbranch_scc1 L5_w3
    s_mov_b32 s32, -1
    s_mov_b32 s33, 119808
    s_cmp_eq_u32 s3, 2
    s_cbranch_scc1 L5_rp_no
    s_add_u32 s40, s20, 7
    s_and_b32 s40, s40, 7
    s_mul_i32 s40, s40, 27
    s_add_u32 s40, s40, s21
    s_mul_i32 s41, s20, 9
    s_add_u32 s41, s41, s21
    s_mul_i32 s42, s3, 5
    s_add_u32 s41, s41, s42
    s_add_u32 s38, s21, s42
    s_add_u32 s41, s41, 189
    s_cmp_lt_u32 s21, 27
    s_cselect_b32 s32, s40, s41
    s_sub_u32 s40, s38, 32
    s_cmp_lt_u32 s40, 4
    s_cselect_b32 s40, s32, -1
    s_cmp_eq_u32 s3, 0
    s_cselect_b32 s32, s32, s40
    s_mul_i32 s33, s3, 18432
    s_add_u32 s33, s33, 82944
    s_cmp_eq_u32 s32, -1
    s_cbranch_scc1 L5_rp_no
    v_mul_u32_u24 v59, 911, v2
    s_mov_b32 s15, 0x00020000
    s_cmp_ge_u32 s32, 216
    s_cbranch_scc1 L5_rp_wo
    s_mov_b64 s[12:13], s[66:67]
    s_mov_b32 s14, 1990656
    s_mul_i32 s36, s32, 171
    s_lshr_b32 s36, s36, 9
    s_mul_i32 s37, s36, 3
    s_sub_u32 s37, s32, s37
    s_mul_i32 s40, s36, 27648
    s_mul_i32 s41, s37, 1152
    s_add_u32 s40, s40, s41
    s_movk_i32 s41, 2304
    s_mov_b32 s42, 16
    s_branch L5_rp_j
L5_rp_wo:
    s_mov_b64 s[12:13], s[68:69]
    s_mov_b32 s14, 663552
    s_sub_u32 s36, s32, 216
    s_lshr_b32 s40, s36, 2
    s_mul_i32 s40, s40, 36
    s_and_b32 s41, s36, 3
    s_lshl_b32 s42, s41, 3
    s_add_u32 s40, s40, s42
    s_and_b32 s41, s41, 2
    s_lshl_b32 s41, s41, 1
    s_add_u32 s40, s40, s41
    s_sub_u32 s41, s36, 64
    s_mul_i32 s41, s41, 72
    s_add_u32 s41, s41, 16
    s_cmp_ge_u32 s36, 64
    s_cselect_b32 s40, s41, s40
    s_cselect_b32 s41, 36864, 0
    s_mul_i32 s40, s40, 1152
    s_mov_b32 s42, 18
L5_rp_j:
    s_mov_b32 m0, s33
    v_lshrrev_b32 v50, s42, v59
    v_mad_u32_u24 v50, v50, s41, v3
    buffer_load_dwordx4 v50, s[12:15], s40 offen offset:0 nt lds
    v_add_u32 v51, 58304, v59
    v_lshrrev_b32 v51, s42, v51
    v_mad_u32_u24 v51, v51, s41, v3
    buffer_load_dwordx4 v51, s[12:15], s40 offen offset:1024 nt lds
    v_add_u32 v52, 116608, v59
    v_lshrrev_b32 v52, s42, v52
    v_mad_u32_u24 v52, v52, s41, v3
    buffer_load_dwordx4 v52, s[12:15], s40 offen offset:2048 nt lds
    v_add_u32 v53, 174912, v59
    v_lshrrev_b32 v53, s42, v53
    v_mad_u32_u24 v53, v53, s41, v3
    buffer_load_dwordx4 v53, s[12:15], s40 offen offset:3072 nt lds
    v_add_u32 v54, 233216, v59
    v_lshrrev_b32 v54, s42, v54
    v_mad_u32_u24 v54, v54, s41, v3
    s_add_u32 s40, s40, 4096
    s_add_u32 m0, s33, 4096
    s_nop 0
    buffer_load_dwordx4 v54, s[12:15], s40 offen offset:0 nt lds
    v_add_u32 v55, 291520, v59
    v_lshrrev_b32 v55, s42, v55
    v_mad_u32_u24 v55, v55, s41, v3
    buffer_load_dwordx4 v55, s[12:15], s40 offen offset:1024 nt lds
    v_add_u32 v56, 349824, v59
    v_lshrrev_b32 v56, s42, v56
    v_mad_u32_u24 v56, v56, s41, v3
    buffer_load_dwordx4 v56, s[12:15], s40 offen offset:2048 nt lds
    v_add_u32 v57, 408128, v59
    v_lshrrev_b32 v57, s42, v57
    v_mad_u32_u24 v57, v57, s41, v3
    buffer_load_dwordx4 v57, s[12:15], s40 offen offset:3072 nt lds
    v_add_u32 v58, 466432, v59
    v_lshrrev_b32 v58, s42, v58
    v_mad_u32_u24 v58, v58, s41, v3
    s_add_u32 s40, s40, 4096
    s_add_u32 m0, s33, 8192
    s_nop 0
    buffer_load_dwordx4 v58, s[12:15], s40 offen offset:0 nt lds
L5_rp_no:
    s_barrier
    s_cmp_eq_u32 s32, -1
    s_cbranch_scc1 L5_q_nou
    v_bfe_u32 v8, v2, 2, 2
    v_mul_u32_u24 v8, 1152, v8
    v_add_u32 v8, s33, v8
    v_lshrrev_b32 v9, 4, v2
    v_and_b32 v10, 3, v2
    v_and_b32 v11, 15, v2
    s_lshr_b32 s42, s36, 2
    s_and_b32 s43, s36, 3
    s_cmp_ge_u32 s32, 216
    s_cbranch_scc1 L5_rq_wo
    v_mul_u32_u24 v4, 288, v9
    v_lshl_add_u32 v4, v10, 3, v4
    v_add_u32 v4, v4, v8
    v_lshl_add_u32 v5, v9, 2, v10
    v_mul_u32_u24 v5, 72, v5
    v_add_u32 v5, v5, v8
    v_mul_u32_u24 v6, 516096, v9
    v_lshl_add_u32 v6, v11, 4, v6
    v_lshrrev_b32 v7, 2, v2
    v_mul_u32_u24 v7, 129024, v7
    v_lshl_add_u32 v7, v10, 4, v7
    s_waitcnt vmcnt(0)
    ds_read_b64_tr_b16 v[10:11], v4 offset:0
    ds_read_b64_tr_b16 v[12:13], v4 offset:4608
    ds_read_b64_tr_b16 v[14:15], v4 offset:40
    ds_read_b64_tr_b16 v[16:17], v4 offset:4648
    ds_read_b64_tr_b16 v[18:19], v4 offset:72
    ds_read_b64_tr_b16 v[20:21], v4 offset:4680
    ds_read_b64_tr_b16 v[22:23], v4 offset:112
    ds_read_b64_tr_b16 v[24:25], v4 offset:4720
    ds_read_b64_tr_b16 v[26:27], v4 offset:144
    ds_read_b64_tr_b16 v[28:29], v4 offset:4752
    ds_read_b64_tr_b16 v[30:31], v4 offset:184
    ds_read_b64_tr_b16 v[32:33], v4 offset:4792
    ds_read_b64_tr_b16 v[34:35], v4 offset:216
    ds_read_b64_tr_b16 v[36:37], v4 offset:4824
    s_mul_i32 s44, s42, 7168
    s_lshl_b32 s43, s43, 8
    s_add_u32 s44, s44, s43
    s_add_u32 s44, s44, 20971520
    s_lshl_b32 s45, s37, 6
    s_add_u32 s45, s45, s44
    s_add_u32 s45, s45, 4096
    s_lshl_b32 s46, s37, 11
    s_lshr_b32 s47, s37, 1
    s_lshl_b32 s47, s47, 10
    s_add_u32 s44, s44, s46
    s_add_u32 s44, s44, s47
    s_waitcnt lgkmcnt(12)
    buffer_store_dwordx4 v[10:13], v6, s[4:7], s44 offen offset:0 sc1
    ds_read_b64_tr_b16 v[38:39], v4 offset:256
    ds_read_b64_tr_b16 v[40:41], v4 offset:4864
    s_waitcnt lgkmcnt(12)
    buffer_store_dwordx4 v[14:17], v6, s[4:7], s44 offen offset:1024 sc1
    ds_read_b64_tr_b16 v[42:43], v5 offset:32
    ds_read_b64_tr_b16 v[44:45], v5 offset:4640
    s_add_u32 s44, s44, 129024
    s_waitcnt lgkmcnt(12)
    buffer_store_dwordx4 v[18:21], v6, s[4:7], s44 offen offset:0 sc1
    s_waitcnt lgkmcnt(10)
    buffer_store_dwordx4 v[22:25], v6, s[4:7], s44 offen offset:1024 sc1
    s_add_u32 s44, s44, 129024
    s_waitcnt lgkmcnt(8)
    buffer_store_dwordx4 v[26:29], v6, s[4:7], s44 offen offset:0 sc1
    s_waitcnt lgkmcnt(6)
    buffer_store_dwordx4 v[30:33], v6, s[4:7], s44 offen offset:1024 sc1
    s_add_u32 s44, s44, 129024
    s_waitcnt lgkmcnt(4)
    buffer_store_dwordx4 v[34:37], v6, s[4:7], s44 offen offset:0 sc1
    s_waitcnt lgkmcnt(2)
    buffer_store_dwordx4 v[38:41], v6, s[4:7], s44 offen offset:1024 sc1
    s_waitcnt lgkmcnt(0)
    buffer_store_dwordx4 v[42:45], v7, s[4:7], s45 offen sc1
    s_branch L5_rq_j
L5_rq_wo:
    v_lshl_add_u32 v4, v9, 5, v8
    v_lshl_add_u32 v4, v10, 3, v4
    v_lshrrev_b32 v5, 1, v10
    v_lshl_add_u32 v5, v9, 1, v5
    v_mul_u32_u24 v5, 144, v5
    v_and_b32 v6, 1, v2
    v_lshl_add_u32 v5, v6, 3, v5
    v_add_u32 v5, v5, v8
    v_lshlrev_b32 v6, 10, v9
    v_lshl_add_u32 v6, v11, 4, v6
    v_lshrrev_b32 v7, 3, v2
    v_mul_u32_u24 v7, 82944, v7
    v_and_b32 v8, 7, v2
    v_lshl_add_u32 v7, v8, 4, v7
    s_waitcnt vmcnt(0)
    ds_read_b64_tr_b16 v[10:11], v4 offset:0
    ds_read_b64_tr_b16 v[12:13], v4 offset:4608
    ds_read_b64_tr_b16 v[14:15], v4 offset:144
    ds_read_b64_tr_b16 v[16:17], v4 offset:4752
    ds_read_b64_tr_b16 v[18:19], v4 offset:288
    ds_read_b64_tr_b16 v[20:21], v4 offset:4896
    ds_read_b64_tr_b16 v[22:23], v4 offset:432
    ds_read_b64_tr_b16 v[24:25], v4 offset:5040
    ds_read_b64_tr_b16 v[26:27], v4 offset:576
    ds_read_b64_tr_b16 v[28:29], v4 offset:5184
    ds_read_b64_tr_b16 v[30:31], v4 offset:720
    ds_read_b64_tr_b16 v[32:33], v4 offset:5328
    ds_read_b64_tr_b16 v[34:35], v4 offset:864
    ds_read_b64_tr_b16 v[36:37], v4 offset:5472
    s_mul_i32 s44, s42, 4608
    s_add_u32 s44, s44, 24117248
    s_lshl_b32 s45, s43, 7
    s_add_u32 s45, s45, s44
    s_add_u32 s45, s45, 4096
    s_lshl_b32 s43, s43, 8
    s_add_u32 s44, s44, s43
    s_waitcnt lgkmcnt(12)
    buffer_store_dwordx4 v[10:13], v6, s[4:7], s44 offen offset:0 sc1
    ds_read_b64_tr_b16 v[38:39], v4 offset:1008
    ds_read_b64_tr_b16 v[40:41], v4 offset:5616
    s_add_u32 s44, s44, 82944
    s_waitcnt lgkmcnt(12)
    buffer_store_dwordx4 v[14:17], v6, s[4:7], s44 offen offset:0 sc1
    ds_read_b64_tr_b16 v[42:43], v5 offset:128
    ds_read_b64_tr_b16 v[44:45], v5 offset:4736
    s_add_u32 s44, s44, 82944
    s_waitcnt lgkmcnt(12)
    buffer_store_dwordx4 v[18:21], v6, s[4:7], s44 offen offset:0 sc1
    s_add_u32 s44, s44, 82944
    s_waitcnt lgkmcnt(10)
    buffer_store_dwordx4 v[22:25], v6, s[4:7], s44 offen offset:0 sc1
    s_add_u32 s44, s44, 82944
    s_waitcnt lgkmcnt(8)
    buffer_store_dwordx4 v[26:29], v6, s[4:7], s44 offen offset:0 sc1
    s_add_u32 s44, s44, 82944
    s_waitcnt lgkmcnt(6)
    buffer_store_dwordx4 v[30:33], v6, s[4:7], s44 offen offset:0 sc1
    s_add_u32 s44, s44, 82944
    s_waitcnt lgkmcnt(4)
    buffer_store_dwordx4 v[34:37], v6, s[4:7], s44 offen offset:0 sc1
    s_add_u32 s44, s44, 82944
    s_waitcnt lgkmcnt(2)
    buffer_store_dwordx4 v[38:41], v6, s[4:7], s44 offen offset:0 sc1
    s_waitcnt lgkmcnt(0)
    buffer_store_dwordx4 v[42:45], v7, s[4:7], s45 offen sc1
L5_rq_j:
    v_mov_b32 v8, 1
    ds_write_b32 v1, v8 offset:32
    s_cmp_lg_u32 s3, 0
    s_cbranch_scc1 L5_kv
L_nw1:
    ds_read_b32 v8, v1 offset:8
    s_waitcnt lgkmcnt(0)
    v_readfirstlane_b32 s94, v8
    s_nop 0
    s_cmp_lg_u32 s94, 0
    s_cbranch_scc1 L_nwx2
    s_cmp_eq_u32 s28, 0
    s_cbranch_scc1 L_nwx2
    s_sub_u32 s28, s28, 1
    s_sleep 1
    s_branch L_nw1
L_nwx2:
    s_mov_b32 s95, s94
    s_waitcnt vmcnt(0)
    s_lshl_b32 s40, s38, 2
    s_add_u32 s40, s40, s27
    s_cmp_ge_u32 s38, 27
    s_cselect_b32 s41, 20, 0
    s_add_u32 s40, s40, s41
    v_mov_b32 v8, 0
    v_mov_b32 v9, s94
    s_mov_b64 exec, 1
    buffer_store_dword v9, v8, s[4:7], s40 offen offset:1792
    s_mov_b64 exec, -1
    s_branch L5_kvx2
L5_w3:
    s_barrier
L5_q_nou:
    s_waitcnt vmcnt(0)
    s_branch L5_kv
L5_w7:
    s_lshl_b32 s40, s29, 1
    s_or_b32 s40, s2, s40
    s_cmp_lg_u32 s40, 1
    s_cbranch_scc1 L5_nnw
    s_memrealtime s[40:41]
    s_mov_b32 s88, s84
    s_mov_b32 s89, s85
    s_mov_b32 s90, 256
    s_mov_b32 s91, 0x00020000
    v_mov_b32 v8, 0
    s_waitcnt lgkmcnt(0)
    s_or_b32 s40, s40, 1
    v_mov_b32 v10, s40
    v_mov_b32 v11, 0
    s_mov_b64 exec, 1
    buffer_atomic_cmpswap v[10:11], v8, s[88:91], 0 offen sc1
    s_mov_b64 exec, -1
L5_nnw:
    s_barrier
    s_mov_b32 s88, s84
    s_mov_b32 s89, s85
    s_mov_b32 s90, 256
    s_mov_b32 s91, 0x00020000
    v_mov_b32 v8, 0
    v_mov_b32 v10, 0
    v_lshlrev_b32 v12, 8, v2
    s_lshl_b32 s40, s20, 5
    s_add_u32 s40, s40, s21
    s_lshl_b32 s40, s40, 8
    s_add_u32 s40, s40, 20054016
    s_add_u32 s14, s86, s40
    s_addc_u32 s15, s87, 0
    s_add_u32 s10, s14, 128
    s_addc_u32 s11, s15, 0
    s_add_u32 s40, s27, 1792
    s_cmp_eq_u32 s21, 30
    s_cselect_b32 s41, 128, 0
    s_add_u32 s40, s40, s41
    s_add_u32 s8, s86, s40
    s_addc_u32 s9, s87, 0
    s_sub_u32 s12, 32, s21
    s_cmp_ge_u32 s21, 30
    s_cselect_b32 s12, s12, 0
    s_cselect_b64 s[8:9], s[8:9], s[14:15]
    s_add_u32 s40, s20, 7
    s_and_b32 s40, s40, 7
    s_add_u32 s41, s20, 8
    s_cmp_eq_u32 s21, 31
    s_cselect_b32 s18, s40, s41
    s_lshl_b32 s18, s18, 2
    s_add_u32 s18, s18, 20054144
L5_pn:
    buffer_load_dword v8, v10, s[88:91], 0 offen sc1
    s_sleep 3
    s_waitcnt vmcnt(30)
    v_readfirstlane_b32 s94, v8
    s_nop 0
    s_cmp_lg_u32 s94, 0
    s_cbranch_scc1 L5_pnx
    s_cmp_eq_u32 s28, 0
    s_cbranch_scc1 L5_pnx
    s_sub_u32 s28, s28, 1
    s_branch L5_pn
L5_pnx:
    v_mov_b32 v9, s94
    ds_write_b32 v1, v9 offset:8
    s_mov_b32 s95, s94
    s_lshl_b32 s40, s2, 2
    s_add_u32 s40, s40, s27
    s_mov_b64 exec, 1
    buffer_store_dword v9, v10, s[4:7], s40 offen offset:2048
    s_mov_b64 exec, -1
    s_mov_b32 s16, 0
    s_mov_b32 s17, 0
L5_pl:
    s_cmp_eq_u32 s12, 3
    s_cbranch_scc1 L5_pl1
    s_load_dwordx16 s[32:47], s[8:9], 0 glc
    s_load_dwordx16 s[48:63], s[8:9], 64 glc
L5_pl1:
    s_load_dwordx16 s[64:79], s[10:11], 0 glc
    s_cmp_eq_u32 s12, 3
    s_waitcnt lgkmcnt(0)
    s_cbranch_scc1 L5_pw
    s_cmp_eq_u64 s[32:33], s[94:95]
    s_cbranch_scc0 L5_pw
    s_cmp_eq_u64 s[34:35], s[94:95]
    s_cbranch_scc0 L5_pw
    s_cmp_eq_u64 s[36:37], s[94:95]
    s_cbranch_scc0 L5_pw
    s_cmp_eq_u64 s[38:39], s[94:95]
    s_cbranch_scc0 L5_pw
    s_cmp_eq_u32 s40, s94
    s_cbranch_scc0 L5_pw
    s_cmp_eq_u32 s12, 2
    s_cbranch_scc1 L5_pld
    s_cmp_eq_u64 s[40:41], s[94:95]
    s_cbranch_scc0 L5_pw
    s_cmp_eq_u64 s[42:43], s[94:95]
    s_cbranch_scc0 L5_pw
    s_cmp_eq_u64 s[44:45], s[94:95]
    s_cbranch_scc0 L5_pw
    s_cmp_eq_u64 s[46:47], s[94:95]
    s_cbranch_scc0 L5_pw
    s_cmp_eq_u64 s[48:49], s[94:95]
    s_cbranch_scc0 L5_pw
    s_cmp_eq_u64 s[50:51], s[94:95]
    s_cbranch_scc0 L5_pw
    s_cmp_eq_u64 s[52:53], s[94:95]
    s_cbranch_scc0 L5_pw
    s_cmp_eq_u64 s[54:55], s[94:95]
    s_cbranch_scc0 L5_pw
    s_cmp_eq_u64 s[56:57], s[94:95]
    s_cbranch_scc0 L5_pw
    s_cmp_eq_u32 s58, s94
    s_cbranch_scc0 L5_pw
    s_cmp_eq_u32 s12, 1
    s_cbranch_scc1 L5_pld
    s_cmp_eq_u64 s[58:59], s[94:95]
    s_cbranch_scc0 L5_pw
    s_cmp_eq_u64 s[60:61], s[94:95]
    s_cbranch_scc0 L5_pw
    s_cmp_eq_u64 s[62:63], s[94:95]
    s_cbranch_scc0 L5_pw
    v_mov_b32 v9, 1
    ds_write_b32 v1, v9
    s_mov_b32 s12, 3
    s_cmp_lt_u32 s21, 24
    s_cbranch_scc1 L5_ptk
    v_mov_b32 v9, 3
    ds_write_b32 v1, v9 offset:40
L5_ptk:
    s_branch L5_pw
L5_pld:
    v_mov_b32 v9, s94
    buffer_store_dword v9, v12, s[4:7], s18 offen sc1
    s_add_u32 s18, s18, 16384
    buffer_store_dword v9, v12, s[4:7], s18 offen sc1
    s_add_u32 s18, s18, 16384
    buffer_store_dword v9, v12, s[4:7], s18 offen sc1
    s_add_u32 s18, s18, 16384
    buffer_store_dword v9, v12, s[4:7], s18 offen sc1
    s_mov_b32 s12, 0
    s_mov_b64 s[8:9], s[14:15]
    v_mov_b32 v9, 1
    s_mov_b64 exec, 1
    ds_add_u32 v1, v9 offset:36
    s_mov_b64 exec, -1
L5_pw:
    s_mov_b32 s13, 0
    s_cmp_eq_u32 s64, s94
    s_cbranch_scc0 L5_pw2
    s_mov_b32 s13, 1
    s_cmp_eq_u32 s65, s94
    s_cbranch_scc0 L5_pw2
    s_mov_b32 s13, 2
    s_cmp_eq_u32 s66, s94
    s_cbranch_scc0 L5_pw2
    s_mov_b32 s13, 3
    s_cmp_eq_u32 s67, s94
    s_cbranch_scc0 L5_pw2
    s_mov_b32 s13, 4
    s_cmp_eq_u32 s68, s94
    s_cbranch_scc0 L5_pw2
    s_mov_b32 s13, 5
    s_cmp_eq_u32 s69, s94
    s_cbranch_scc0 L5_pw2
    s_mov_b32 s13, 6
    s_cmp_eq_u32 s70, s94
    s_cbranch_scc0 L5_pw2
    s_mov_b32 s13, 7
    s_cmp_eq_u32 s71, s94
    s_cbranch_scc0 L5_pw2
    s_mov_b32 s13, 8
L5_pw2:
    s_cmp_le_u32 s13, s16
    s_cbranch_scc1 L5_pg
    s_mov_b32 s16, s13
    s_mul_i32 s40, s13, 27
    v_mov_b32 v9, s40
    ds_write_b32 v1, v9 offset:20
L5_pg:
    s_cmp_lg_u32 s12, 3
    s_cbranch_scc1 L5_pf
    s_cmp_lg_u32 s16, 8
    s_cbranch_scc1 L5_pf2
    s_cmp_eq_u64 s[72:73], s[94:95]
    s_cbranch_scc0 L5_pf2
    s_cmp_eq_u64 s[74:75], s[94:95]
    s_cbranch_scc0 L5_pf2
    s_cmp_eq_u64 s[76:77], s[94:95]
    s_cbranch_scc0 L5_pf2
    s_cmp_eq_u64 s[78:79], s[94:95]
    s_cbranch_scc0 L5_pf2
    s_branch L5_px
L5_pf2:
    s_cmp_eq_u32 s28, 0
    s_cbranch_scc1 L5_px
    s_sub_u32 s28, s28, 1
    s_branch L5_pl
L5_pf:
    s_add_u32 s17, s17, 1
    s_and_b32 s40, s17, 15
    s_or_b32 s40, s40, s29
    s_cmp_lg_u32 s40, 0
    s_cbranch_scc1 L5_pf2
L5_pu:
    buffer_load_dwordx4 v[20:23], v3, s[4:7], s27 offen offset:2048 sc1
    v_lshlrev_b32 v24, 2, v2
    s_mov_b32 s43, 0
    s_mov_b64 s[44:45], 0
    s_mov_b32 s41, 0
    s_waitcnt vmcnt(0)
    v_cmp_eq_u32 s[50:51], s94, v20
    s_nop 0
    s_bcnt1_i32_b64 s42, s[50:51]
    s_add_u32 s43, s43, s42
    s_or_b64 s[44:45], s[44:45], s[50:51]
    v_add_u32 v25, 0, v24
    v_cmp_gt_u32 vcc, s2, v25
    s_nop 0
    s_and_b64 s[48:49], vcc, s[50:51]
    s_bcnt1_i32_b64 s48, s[48:49]
    s_add_u32 s41, s41, s48
    v_cmp_eq_u32 s[50:51], s94, v21
    s_nop 0
    s_bcnt1_i32_b64 s42, s[50:51]
    s_add_u32 s43, s43, s42
    s_or_b64 s[44:45], s[44:45], s[50:51]
    v_add_u32 v25, 1, v24
    v_cmp_gt_u32 vcc, s2, v25
    s_nop 0
    s_and_b64 s[48:49], vcc, s[50:51]
    s_bcnt1_i32_b64 s48, s[48:49]
    s_add_u32 s41, s41, s48
    v_cmp_eq_u32 s[50:51], s94, v22
    s_nop 0
    s_bcnt1_i32_b64 s42, s[50:51]
    s_add_u32 s43, s43, s42
    s_or_b64 s[44:45], s[44:45], s[50:51]
    v_add_u32 v25, 2, v24
    v_cmp_gt_u32 vcc, s2, v25
    s_nop 0
    s_and_b64 s[48:49], vcc, s[50:51]
    s_bcnt1_i32_b64 s48, s[48:49]
    s_add_u32 s41, s41, s48
    v_cmp_eq_u32 s[50:51], s94, v23
    s_nop 0
    s_bcnt1_i32_b64 s42, s[50:51]
    s_add_u32 s43, s43, s42
    s_or_b64 s[44:45], s[44:45], s[50:51]
    v_add_u32 v25, 3, v24
    v_cmp_gt_u32 vcc, s2, v25
    s_nop 0
    s_and_b64 s[48:49], vcc, s[50:51]
    s_bcnt1_i32_b64 s48, s[48:49]
    s_add_u32 s41, s41, s48
    s_cmp_lt_u32 s43, 32
    s_cbranch_scc1 L5_pf2
    s_lshr_b64 s[48:49], s[44:45], 1
    s_or_b64 s[44:45], s[44:45], s[48:49]
    s_mov_b32 s48, 0x55555555
    s_mov_b32 s49, 0x55555555
    s_and_b64 s[44:45], s[44:45], s[48:49]
    s_cmp_eq_u64 s[44:45], s[48:49]
    s_cbranch_scc1 L5_pf2
    s_and_b32 s41, s41, 31
    v_mov_b32 v8, 2
    v_mov_b32 v9, s41
    ds_write_b64 v1, v[8:9]
    v_mov_b32 v9, 216
    ds_write_b32 v1, v9 offset:20
    ds_write_b32 v1, v9 offset:36
    ds_write_b32 v1, v9 offset:40
    s_branch L5_fallback
L5_px:
    s_load_dwordx16 s[64:79], s[0:1], 0
    s_load_dwordx8 s[80:87], s[0:1], 64
    v_mov_b32 v8, 1
    s_mov_b64 exec, 1
    ds_add_u32 v1, v8 offset:12
    s_mov_b64 exec, -1
L_lw3:
    ds_read_b32 v8, v1 offset:44
    s_waitcnt lgkmcnt(0)
    v_readfirstlane_b32 s40, v8
    s_nop 0
    s_cmp_ge_u32 s40, 4
    s_cbranch_scc1 L_lwx4
    s_cmp_eq_u32 s28, 0
    s_cbranch_scc1 L_lwx4
    s_sub_u32 s28, s28, 1
    s_sleep 2
    s_branch L_lw3
L_lwx4:
    v_lshlrev_b32 v4, 7, v2
    s_mul_i32 s40, s21, 12288
    s_add_u32 s40, s40, s26
    s_add_u32 s42, s40, 8192
    s_lshl_b32 s41, s20, 5
    s_add_u32 s41, s41, s21
    s_mul_i32 s41, s41, 9216
    s_add_u32 s41, s41, 8388608
    s_add_u32 s43, s41, 8192
    buffer_load_dword a136, v4, s[4:7], s40 offen
    buffer_load_dword a137, v4, s[4:7], s41 offen
    s_mov_b32 exec_hi, 0
    buffer_load_dword a138, v4, s[4:7], s42 offen
    s_mov_b64 exec, 0xff
    buffer_load_dword a139, v4, s[4:7], s43 offen
    s_mov_b64 exec, -1
    s_branch L5_aux
L5_a:
    s_cmp_eq_u32 s3, 6
    s_cbranch_scc1 L5_w6
    s_barrier
    s_cmp_eq_u32 s3, 4
    s_cselect_b64 s[8:9], s[72:73], s[74:75]
    s_cselect_b32 s41, 0, 10080
    s_add_u32 s41, s41, 138240
    s_mov_b32 s10, 2359296
    s_mov_b32 s11, 0x00020000
    v_mul_u32_u24 v4, 57, v2
    v_lshrrev_b32 v4, 9, v4
    v_mul_u32_u24 v5, 9, v4
    v_sub_u32 v5, v2, v5
    v_mul_u32_u24 v4, 1152, v4
    v_lshl_add_u32 v4, v5, 4, v4
    s_mul_i32 s40, s21, 73728
    s_mul_i32 s42, s20, 144
    s_add_u32 s40, s40, s42
    s_sub_u32 s40, s40, 4608
    v_add_u32 v4, s40, v4
    s_mov_b32 exec_hi, 0x7fffffff
    s_add_u32 m0, s41, 0
    s_nop 0
    buffer_load_dwordx4 v4, s[8:11], 0 offen nt lds
    s_add_u32 m0, s41, 1008
    v_add_u32 v4, 8064, v4
    buffer_load_dwordx4 v4, s[8:11], 0 offen nt lds
    s_add_u32 m0, s41, 2016
    v_add_u32 v4, 8064, v4
    buffer_load_dwordx4 v4, s[8:11], 0 offen nt lds
    s_add_u32 m0, s41, 3024
    v_add_u32 v4, 8064, v4
    buffer_load_dwordx4 v4, s[8:11], 0 offen nt lds
    s_add_u32 m0, s41, 4032
    v_add_u32 v4, 8064, v4
    buffer_load_dwordx4 v4, s[8:11], 0 offen nt lds
    s_add_u32 m0, s41, 5040
    v_add_u32 v4, 8064, v4
    buffer_load_dwordx4 v4, s[8:11], 0 offen nt lds
    s_add_u32 m0, s41, 6048
    v_add_u32 v4, 8064, v4
    buffer_load_dwordx4 v4, s[8:11], 0 offen nt lds
    s_add_u32 m0, s41, 7056
    v_add_u32 v4, 8064, v4
    buffer_load_dwordx4 v4, s[8:11], 0 offen nt lds
    s_add_u32 m0, s41, 8064
    v_add_u32 v4, 8064, v4
    buffer_load_dwordx4 v4, s[8:11], 0 offen nt lds
    s_add_u32 m0, s41, 9072
    v_add_u32 v4, 8064, v4
    s_mov_b32 exec_hi, 0x1fff
    buffer_load_dwordx4 v4, s[8:11], 0 offen nt lds
    s_mov_b64 exec, -1
    s_cmp_ge_u32 s21, 24
    s_cbranch_scc1 L5_a_nc
    s_mov_b32 s12, s80
    s_mov_b32 s13, s81
    s_mov_b32 s14, 1152
    s_mov_b32 s15, 0x00020000
    s_mul_i32 s41, s20, 24
    s_add_u32 s40, s21, s41
    s_mul_i32 s40, s40, 3
    s_add_u32 s40, s40, s31
    s_lshl_b32 s43, s40, 1
    v_mov_b32 v7, 0
    buffer_load_ushort v110, v7, s[12:15], s43 offen
    s_mul_i32 s41, s31, 21248
    v_mov_b32 v8, 0
    v_mov_b32 v9, 0
    v_mov_b32 v10, 0
    v_mov_b32 v11, 0
    v_add_u32 v12, 16640, v3
    v_subrev_u32 v13, 32, v2
    v_lshrrev_b32 v14, 2, v13
    v_mul_u32_u24 v14, 4160, v14
    v_and_b32 v13, 3, v13
    v_lshl_add_u32 v13, v13, 4, v14
    v_add_u32 v13, 4096, v13
    v_cmp_gt_u32 vcc, 32, v2
    s_nop 1
    v_cndmask_b32 v12, v13, v12, vcc
    v_add_u32 v12, s41, v12
    s_mov_b32 s40, -1
    s_mov_b32 s41, 0xffff
    s_mov_b64 exec, s[40:41]
    ds_write_b128 v12, v[8:11]
    s_mov_b64 exec, -1
L5_a_nc:
    s_waitcnt vmcnt(0)
    v_mov_b32 v8, 1
    s_mov_b64 exec, 1
    ds_add_u32 v1, v8 offset:24
    s_mov_b64 exec, -1
    s_branch L5_kv
L5_w6:
    s_cmp_ge_u32 s21, 24
    s_cbranch_scc1 L5_a_nc6
    s_mov_b32 s12, s80
    s_mov_b32 s13, s81
    s_mov_b32 s14, 1152
    s_mov_b32 s15, 0x00020000
    s_mul_i32 s41, s20, 24
    s_add_u32 s40, s21, s41
    s_mul_i32 s40, s40, 3
    s_add_u32 s40, s40, s31
    s_lshl_b32 s43, s40, 1
    v_mov_b32 v7, 0
    buffer_load_ushort v110, v7, s[12:15], s43 offen
    s_mul_i32 s41, s31, 21248
    v_mov_b32 v8, 0
    v_mov_b32 v9, 0
    v_mov_b32 v10, 0
    v_mov_b32 v11, 0
    v_add_u32 v12, 16640, v3
    v_subrev_u32 v13, 32, v2
    v_lshrrev_b32 v14, 2, v13
    v_mul_u32_u24 v14, 4160, v14
    v_and_b32 v13, 3, v13
    v_lshl_add_u32 v13, v13, 4, v14
    v_add_u32 v13, 4096, v13
    v_cmp_gt_u32 vcc, 32, v2
    s_nop 1
    v_cndmask_b32 v12, v13, v12, vcc
    v_add_u32 v12, s41, v12
    s_mov_b32 s40, -1
    s_mov_b32 s41, 0xffff
    s_mov_b64 exec, s[40:41]
    ds_write_b128 v12, v[8:11]
    s_mov_b64 exec, -1
L5_a_nc6:
    s_barrier
    s_waitcnt vmcnt(0)
L5_kv:
    v_lshrrev_b32 v4, 4, v2
    v_bfe_u32 v5, v2, 1, 1
    v_lshl_add_u32 v4, v4, 1, v5
    v_bfe_u32 v5, v2, 2, 2
    v_lshl_add_u32 v4, v4, 3, v5
    v_mul_u32_u24 v4, 144, v4
    v_and_b32 v5, 1, v2
    v_lshl_add_u32 v7, v5, 3, v4
    v_add_u32 v7, 138240, v7
    v_and_b32 v5, 7, v2
    v_mul_u32_u24 v5, 8448, v5
    v_lshrrev_b32 v6, 3, v2
    v_sub_u32 v6, 7, v6
    v_lshl_add_u32 v5, v6, 4, v5
    s_mov_b32 s19, 0x3f803f80
L_lw5:
    ds_read_b32 v8, v1 offset:24
    s_waitcnt lgkmcnt(0)
    v_readfirstlane_b32 s40, v8
    s_nop 0
    s_cmp_ge_u32 s40, 2
    s_cbranch_scc1 L_lwx6
    s_cmp_eq_u32 s28, 0
    s_cbranch_scc1 L_lwx6
    s_sub_u32 s28, s28, 1
    s_branch L_lw5
L_lwx6:
L5_kvu:
    s_lshl_b32 s40, s34, 4
    v_add_u32 v4, s40, v7
    ds_read_b64_tr_b16 v[40:41], v4 offset:0
    ds_read_b64_tr_b16 v[42:43], v4 offset:576
    ds_read_b64_tr_b16 v[44:45], v4 offset:1152
    ds_read_b64_tr_b16 v[58:59], v4 offset:10080
    ds_read_b64_tr_b16 v[60:61], v4 offset:10656
    ds_read_b64_tr_b16 v[62:63], v4 offset:11232
    v_and_b32 v8, 0xffff, v104
    v_lshlrev_b32 v9, 16, v104
    v_lshrrev_b32 v10, 16, v104
    v_and_b32 v11, 0xffff0000, v104
    v_and_b32 v12, 0xffff, v105
    v_lshlrev_b32 v13, 16, v105
    v_lshrrev_b32 v14, 16, v105
    v_and_b32 v15, 0xffff0000, v105
    s_mul_i32 s16, s20, 9
    s_add_u32 s16, s16, s34
    s_mul_i32 s16, s16, 67584
    s_add_u32 s18, s16, 0
    s_lshl_b32 s17, s21, 7
    s_sub_u32 s16, s18, s17
    s_add_u32 s16, s16, 3968
    s_add_u32 s17, s16, 4224
    s_cmp_lg_u32 s21, 0
    s_cbranch_scc1 L5_nzt
    v_mov_b32 v76, 0
    v_mov_b32 v77, 0
    v_mov_b32 v78, 0
    v_mov_b32 v79, 0
    v_mul_u32_u24 v6, 4224, v2
    v_add_u32 v6, 4096, v6
    s_mov_b64 exec, 0xffff
    buffer_store_dwordx4 v[76:79], v6, s[4:7], s18 offen
    s_mov_b64 exec, -1
L5_nzt:
    s_waitcnt lgkmcnt(3)
    v_dot2_f32_bf16 v76, v40, v14, 0
    v_dot2_f32_bf16 v77, v40, v15, 0
    v_dot2_f32_bf16 v78, v41, v14, 0
    v_dot2_f32_bf16 v79, v41, v15, 0
    v_dot2_f32_bf16 v80, v42, v14, 0
    v_dot2_f32_bf16 v81, v42, v15, 0
    v_dot2_f32_bf16 v82, v43, v14, 0
    v_dot2_f32_bf16 v83, v43, v15, 0
    v_dot2_f32_bf16 v84, v44, v14, 0
    v_dot2_f32_bf16 v85, v40, v13, 0
    v_dot2_f32_bf16 v86, v41, v12, 0
    v_dot2_f32_bf16 v87, v41, v13, 0
    v_dot2_f32_bf16 v88, v42, v12, 0
    v_dot2_f32_bf16 v89, v42, v13, 0
    v_dot2_f32_bf16 v90, v43, v12, 0
    v_dot2_f32_bf16 v91, v43, v13, 0
    v_dot2_f32_bf16 v92, v44, v12, 0
    v_dot2_f32_bf16 v93, v44, v13, 0
    v_cvt_pk_bf16_f32 v76, v76, v85
    v_cvt_pk_bf16_f32 v77, v77, v86
    v_cvt_pk_bf16_f32 v78, v78, v87
    v_cvt_pk_bf16_f32 v79, v79, v88
    v_cvt_pk_bf16_f32 v80, v80, v89
    v_cvt_pk_bf16_f32 v81, v81, v90
    v_cvt_pk_bf16_f32 v82, v82, v91
    v_cvt_pk_bf16_f32 v83, v83, v92
    v_cvt_pk_bf16_f32 v84, v84, v93
    v_dot2_f32_bf16 v76, v76, s19, 0
    v_dot2_f32_bf16 v77, v77, s19, 0
    v_dot2_f32_bf16 v78, v78, s19, 0
    v_dot2_f32_bf16 v79, v79, s19, 0
    v_dot2_f32_bf16 v80, v80, s19, 0
    v_dot2_f32_bf16 v81, v81, s19, 0
    v_dot2_f32_bf16 v82, v82, s19, 0
    v_dot2_f32_bf16 v83, v83, s19, 0
    v_dot2_f32_bf16 v84, v84, s19, 0
    v_dot2_f32_bf16 v85, v41, v10, 0
    v_dot2_f32_bf16 v86, v41, v11, 0
    v_dot2_f32_bf16 v87, v42, v10, 0
    v_dot2_f32_bf16 v88, v42, v11, 0
    v_dot2_f32_bf16 v89, v43, v10, 0
    v_dot2_f32_bf16 v90, v43, v11, 0
    v_dot2_f32_bf16 v91, v44, v10, 0
    v_dot2_f32_bf16 v92, v44, v11, 0
    v_dot2_f32_bf16 v93, v45, v10, 0
    v_cvt_pk_bf16_f32 v76, v76, v85
    v_cvt_pk_bf16_f32 v77, v77, v86
    v_cvt_pk_bf16_f32 v78, v78, v87
    v_cvt_pk_bf16_f32 v79, v79, v88
    v_cvt_pk_bf16_f32 v80, v80, v89
    v_cvt_pk_bf16_f32 v81, v81, v90
    v_cvt_pk_bf16_f32 v82, v82, v91
    v_cvt_pk_bf16_f32 v83, v83, v92
    v_cvt_pk_bf16_f32 v84, v84, v93
    v_dot2_f32_bf16 v76, v76, s19, 0
    v_dot2_f32_bf16 v77, v77, s19, 0
    v_dot2_f32_bf16 v78, v78, s19, 0
    v_dot2_f32_bf16 v79, v79, s19, 0
    v_dot2_f32_bf16 v80, v80, s19, 0
    v_dot2_f32_bf16 v81, v81, s19, 0
    v_dot2_f32_bf16 v82, v82, s19, 0
    v_dot2_f32_bf16 v83, v83, s19, 0
    v_dot2_f32_bf16 v84, v84, s19, 0
    v_dot2_f32_bf16 v85, v41, v9, 0
    v_dot2_f32_bf16 v86, v42, v8, 0
    v_dot2_f32_bf16 v87, v42, v9, 0
    v_dot2_f32_bf16 v88, v43, v8, 0
    v_dot2_f32_bf16 v89, v43, v9, 0
    v_dot2_f32_bf16 v90, v44, v8, 0
    v_dot2_f32_bf16 v91, v44, v9, 0
    v_dot2_f32_bf16 v92, v45, v8, 0
    v_dot2_f32_bf16 v93, v45, v9, 0
    v_cvt_pk_bf16_f32 v76, v76, v85
    v_cvt_pk_bf16_f32 v77, v77, v86
    v_cvt_pk_bf16_f32 v78, v78, v87
    v_cvt_pk_bf16_f32 v79, v79, v88
    v_cvt_pk_bf16_f32 v80, v80, v89
    v_cvt_pk_bf16_f32 v81, v81, v90
    v_cvt_pk_bf16_f32 v82, v82, v91
    v_cvt_pk_bf16_f32 v83, v83, v92
    v_cvt_pk_bf16_f32 v84, v84, v93
    v_dot2_f32_bf16 v76, v76, s19, 0
    v_dot2_f32_bf16 v77, v77, s19, 0
    v_dot2_f32_bf16 v78, v78, s19, 0
    v_dot2_f32_bf16 v79, v79, s19, 0
    v_dot2_f32_bf16 v80, v80, s19, 0
    v_dot2_f32_bf16 v81, v81, s19, 0
    v_dot2_f32_bf16 v82, v82, s19, 0
    v_dot2_f32_bf16 v83, v83, s19, 0
    v_dot2_f32_bf16 v84, v84, s19, 0
    v_cvt_pk_bf16_f32 v76, 0, v76
    v_cvt_pk_bf16_f32 v77, v77, 0
    v_cvt_pk_bf16_f32 v78, 0, v78
    v_cvt_pk_bf16_f32 v79, v79, 0
    v_cvt_pk_bf16_f32 v80, 0, v80
    v_cvt_pk_bf16_f32 v81, v81, 0
    v_cvt_pk_bf16_f32 v82, 0, v82
    v_cvt_pk_bf16_f32 v83, v83, 0
    v_cvt_pk_bf16_f32 v84, 0, v84
    s_waitcnt lgkmcnt(0)
    v_dot2_f32_bf16 v76, v76, v59, 0
    v_dot2_f32_bf16 v77, v77, v60, 0
    v_dot2_f32_bf16 v78, v78, v60, 0
    v_dot2_f32_bf16 v79, v79, v61, 0
    v_dot2_f32_bf16 v80, v80, v61, 0
    v_dot2_f32_bf16 v81, v81, v62, 0
    v_dot2_f32_bf16 v82, v82, v62, 0
    v_dot2_f32_bf16 v83, v83, v63, 0
    v_dot2_f32_bf16 v84, v84, v63, 0
    s_nop 2
    v_cvt_pk_bf16_f32 v94, v84, v83
    v_cvt_pk_bf16_f32 v95, v82, v81
    v_cvt_pk_bf16_f32 v96, v80, v79
    v_cvt_pk_bf16_f32 v97, v78, v77
    v_cvt_pk_bf16_f32 v98, v83, v82
    v_cvt_pk_bf16_f32 v99, v81, v80
    v_cvt_pk_bf16_f32 v100, v79, v78
    v_cvt_pk_bf16_f32 v101, v77, v76
    buffer_store_dwordx4 v[94:97], v5, s[4:7], s16 offen
    buffer_store_dwordx4 v[98:101], v5, s[4:7], s17 offen
    s_mov_b32 s34, s35
    s_mov_b32 s35, -1
    v_mov_b32 v104, v106
    v_mov_b32 v105, v107
    s_cmp_lg_u32 s34, -1
    s_cbranch_scc1 L5_kvu
    s_waitcnt vmcnt(0)
L_nw7:
    ds_read_b32 v8, v1 offset:8
    s_waitcnt lgkmcnt(0)
    v_readfirstlane_b32 s94, v8
    s_nop 0
    s_cmp_lg_u32 s94, 0
    s_cbranch_scc1 L_nwx8
    s_cmp_eq_u32 s28, 0
    s_cbranch_scc1 L_nwx8
    s_sub_u32 s28, s28, 1
    s_sleep 1
    s_branch L_nw7
L_nwx8:
    s_mov_b32 s95, s94
    s_cmp_lg_u32 s3, 1
    s_cbranch_scc1 L5_mdx
    s_cmp_eq_u32 s32, -1
    s_cbranch_scc1 L5_mdx
    s_lshl_b32 s40, s38, 2
    s_add_u32 s40, s40, s27
    s_cmp_ge_u32 s38, 27
    s_cselect_b32 s41, 20, 0
    s_add_u32 s40, s40, s41
    v_mov_b32 v8, 0
    v_mov_b32 v9, s94
    s_mov_b64 exec, 1
    buffer_store_dword v9, v8, s[4:7], s40 offen offset:1792
    s_mov_b64 exec, -1
L5_mdx:
    v_mov_b32 v8, 1
    s_mov_b64 exec, 1
    ds_add_rtn_u32 v9, v1, v8 offset:56
    s_mov_b64 exec, -1
    s_lshl_b32 s40, s21, 2
    s_lshl_b32 s42, s20, 13
    s_add_u32 s40, s40, s42
    s_add_u32 s40, s40, 20054016
    v_lshlrev_b32 v10, 8, v2
    v_mov_b32 v11, s94
    s_waitcnt lgkmcnt(0)
    v_readfirstlane_b32 s41, v9
    s_nop 0
    s_cmp_lg_u32 s41, 5
    s_cbranch_scc1 L5_kvx
    s_mov_b32 exec_hi, 0
    buffer_store_dword v11, v10, s[4:7], s40 offen
    s_mov_b64 exec, -1
    v_mov_b32 v8, 1
    s_mov_b64 exec, 1
    ds_add_u32 v1, v8 offset:36
    s_mov_b64 exec, -1
L5_kvx:
L5_kvx2:
    s_cmp_lt_u32 s3, 4
    s_cbranch_scc1 L5_q
    s_cmp_ge_u32 s21, 24
    s_cbranch_scc1 L5_aux
    s_cmp_lg_u32 s31, 2
    s_cbranch_scc1 L5_cv0
L_lw9:
    ds_read_b32 v8, v1 offset:36
    s_waitcnt lgkmcnt(0)
    v_readfirstlane_b32 s40, v8
    s_nop 0
    s_cmp_ge_u32 s40, 1
    s_cbranch_scc1 L_lwx10
    s_cmp_eq_u32 s28, 0
    s_cbranch_scc1 L_lwx10
    s_sub_u32 s28, s28, 1
    s_sleep 1
    s_branch L_lw9
L_lwx10:
    s_mov_b32 s8, s78
    s_mov_b32 s9, s79
    s_mov_b32 s10, 2359296
    s_mov_b32 s11, 0x00020000
    s_mul_i32 s41, s20, 24
    s_add_u32 s40, s21, s41
    s_mul_i32 s40, s40, 12288
    s_mov_b32 m0, 17152
    s_nop 0
    buffer_load_dwordx4 v3, s[8:11], s40 offen offset:0 nt lds
    buffer_load_dwordx4 v3, s[8:11], s40 offen offset:1024 nt lds
    buffer_load_dwordx4 v3, s[8:11], s40 offen offset:2048 nt lds
    buffer_load_dwordx4 v3, s[8:11], s40 offen offset:3072 nt lds
    s_mov_b32 m0, 38400
    s_add_u32 s40, s40, 4096
    buffer_load_dwordx4 v3, s[8:11], s40 offen offset:0 nt lds
    buffer_load_dwordx4 v3, s[8:11], s40 offen offset:1024 nt lds
    buffer_load_dwordx4 v3, s[8:11], s40 offen offset:2048 nt lds
    buffer_load_dwordx4 v3, s[8:11], s40 offen offset:3072 nt lds
    s_mov_b32 m0, 59648
    s_add_u32 s40, s40, 4096
    buffer_load_dwordx4 v3, s[8:11], s40 offen offset:0 nt lds
    buffer_load_dwordx4 v3, s[8:11], s40 offen offset:1024 nt lds
    buffer_load_dwordx4 v3, s[8:11], s40 offen offset:2048 nt lds
    buffer_load_dwordx4 v3, s[8:11], s40 offen offset:3072 nt lds
L5_cv0:
    s_mul_i32 s40, s21, 3
    s_add_u32 s40, s40, s31
    s_mul_i32 s41, s20, 72
    s_add_u32 s39, s40, s41
    s_mul_i32 s39, s39, 8448
    s_add_u32 s39, s39, 0
    s_mul_i32 s37, s20, 9216
    s_lshl_b32 s40, s40, 7
    s_add_u32 s37, s37, s40
    s_add_u32 s37, s37, 5242880
    s_mul_i32 s35, s31, 21248
    v_and_b32 v18, 15, v2
    v_lshrrev_b32 v19, 4, v2
    v_and_b32 v20, 7, v18
    v_lshrrev_b32 v21, 3, v18
    v_lshl_add_u32 v20, v20, 1, v21
    v_sub_u32 v21, 3, v20
    v_and_b32 v21, 3, v21
    v_add_u32 v20, v20, v21
    v_and_b32 v22, 1, v19
    v_lshrrev_b32 v23, 1, v19
    v_lshlrev_b32 v4, 3, v22
    v_sub_u32 v4, v4, v20
    v_lshlrev_b32 v5, 4, v23
    v_sub_u32 v4, v4, v5
    v_lshlrev_b32 v4, 1, v4
    v_mul_u32_u24 v21, 4160, v21
    v_add_u32 v4, v4, v21
    s_add_u32 s40, s35, 446
    v_add_u32 v4, s40, v4
    v_sub_u32 v5, v18, v23
    v_lshlrev_b32 v5, 5, v5
    v_lshl_add_u32 v5, v22, 4, v5
    s_add_u32 s40, s35, 17088
    v_add_u32 v5, s40, v5
    v_lshlrev_b32 v6, 5, v18
    v_lshl_add_u32 v6, v22, 4, v6
    v_sub_u32 v6, 496, v6
    s_add_u32 s40, s35, 0
    v_add_u32 v6, s40, v6
    v_lshrrev_b32 v7, 3, v18
    v_and_b32 v20, 1, v18
    v_lshl_add_u32 v7, v7, 1, v20
    v_mul_u32_u24 v7, 73728, v7
    v_bfe_u32 v20, v18, 1, 2
    v_lshl_add_u32 v7, v20, 5, v7
    v_lshl_add_u32 v7, v19, 3, v7
    v_lshlrev_b32 v20, 16, v110
    v_cmp_gt_u32 vcc, 32, v2
    s_nop 1
    v_cndmask_b32 v110, v110, v20, vcc
    s_mov_b32 s36, 0x3f803f80
    v_mov_b32 v8, 0
    v_mov_b32 v9, 0
    v_mov_b32 v10, 0
    v_mov_b32 v11, 0
    v_mov_b32 v12, 0
    v_mov_b32 v13, 0
    v_mov_b32 v14, 0
    v_mov_b32 v15, 0
    v_mov_b32 v16, 0
    v_mov_b32 v17, 0
    v_mov_b32 v18, 0
    v_mov_b32 v19, 0
    v_mov_b32 v20, 0
    v_mov_b32 v21, 0
    v_mov_b32 v22, 0
    v_mov_b32 v23, 0
    v_mov_b32 v24, 0
    v_mov_b32 v25, 0
    v_mov_b32 v26, 0
    v_mov_b32 v27, 0
    v_mov_b32 v28, 0
    v_mov_b32 v29, 0
    v_mov_b32 v30, 0
    v_mov_b32 v31, 0
    v_mov_b32 v32, 0
    v_mov_b32 v33, 0
    v_mov_b32 v34, 0
    v_mov_b32 v35, 0
    v_mov_b32 v36, 0
    v_mov_b32 v37, 0
    v_mov_b32 v38, 0
    v_mov_b32 v39, 0
L_tok11:
    ds_read_b64 v[108:109], v1
    s_waitcnt lgkmcnt(0)
    v_readfirstlane_b32 s40, v108
    v_readfirstlane_b32 s41, v109
    s_cmp_eq_u32 s40, 2
    s_cbranch_scc1 L5_fallback
    s_cmp_eq_u32 s40, 1
    s_cbranch_scc1 L_tokx12
    s_cmp_eq_u32 s28, 0
    s_cbranch_scc1 L_tokx12
    s_sub_u32 s28, s28, 1
    s_sleep 1
    s_branch L_tok11
L_tokx12:
    s_add_u32 s40, s39, 0
    s_add_u32 m0, s35, 0
    s_nop 0
    buffer_load_dwordx4 v3, s[4:7], s40 offen offset:0 sc1 lds
    buffer_load_dwordx4 v3, s[4:7], s40 offen offset:1024 sc1 lds
    buffer_load_dwordx4 v3, s[4:7], s40 offen offset:2048 sc1 lds
    buffer_load_dwordx4 v3, s[4:7], s40 offen offset:3072 sc1 lds
    s_add_u32 s40, s39, 4224
    s_add_u32 m0, s35, 4160
    s_nop 0
    buffer_load_dwordx4 v3, s[4:7], s40 offen offset:0 sc1 lds
    buffer_load_dwordx4 v3, s[4:7], s40 offen offset:1024 sc1 lds
    buffer_load_dwordx4 v3, s[4:7], s40 offen offset:2048 sc1 lds
    buffer_load_dwordx4 v3, s[4:7], s40 offen offset:3072 sc1 lds
    s_add_u32 s40, s39, 4
    s_add_u32 m0, s35, 8320
    s_nop 0
    buffer_load_dwordx4 v3, s[4:7], s40 offen offset:0 sc1 lds
    buffer_load_dwordx4 v3, s[4:7], s40 offen offset:1024 sc1 lds
    buffer_load_dwordx4 v3, s[4:7], s40 offen offset:2048 sc1 lds
    buffer_load_dwordx4 v3, s[4:7], s40 offen offset:3072 sc1 lds
    s_add_u32 s40, s39, 4228
    s_add_u32 m0, s35, 12480
    s_nop 0
    buffer_load_dwordx4 v3, s[4:7], s40 offen offset:0 sc1 lds
    buffer_load_dwordx4 v3, s[4:7], s40 offen offset:1024 sc1 lds
    buffer_load_dwordx4 v3, s[4:7], s40 offen offset:2048 sc1 lds
    buffer_load_dwordx4 v3, s[4:7], s40 offen offset:3072 sc1 lds
    v_mov_b32 v108, 1
    s_mov_b64 exec, 1
    ds_add_u32 v1, v108 offset:40
    s_mov_b64 exec, -1
    s_mov_b32 s38, 0
    v_mov_b32 v108, 1
    s_waitcnt vmcnt(0)
    s_cmp_lg_u32 s31, 2
    s_cbranch_scc1 L5_cvs
    ds_write_b32 v1, v108 offset:16
L5_cvs:
L_lw13:
    ds_read_b32 v108, v1 offset:16
    s_waitcnt lgkmcnt(0)
    v_readfirstlane_b32 s40, v108
    s_nop 0
    s_cmp_ge_u32 s40, 1
    s_cbranch_scc1 L_lwx14
    s_cmp_eq_u32 s28, 0
    s_cbranch_scc1 L_lwx14
    s_sub_u32 s28, s28, 1
    s_branch L_lw13
L_lwx14:
    ds_read_b128 a[32:35], v5 offset:64
    ds_read_b64 a[28:29], v4 offset:64
    ds_read_b64 a[30:31], v4 offset:72
    ds_read_b128 a[36:39], v5 offset:576
    ds_read_b64 a[24:25], v4 offset:576
    ds_read_b64 a[26:27], v4 offset:584
    ds_read_b128 a[40:43], v5 offset:1088
    ds_read_b64 a[20:21], v4 offset:1088
    ds_read_b64 a[22:23], v4 offset:1096
    ds_read_b128 a[44:47], v5 offset:1600
    ds_read_b64 a[16:17], v4 offset:1600
    ds_read_b64 a[18:19], v4 offset:1608
    ds_read_b128 a[48:51], v5 offset:2112
    ds_read_b64 a[12:13], v4 offset:2112
    ds_read_b64 a[14:15], v4 offset:2120
    ds_read_b128 a[52:55], v5 offset:2624
    ds_read_b64 a[8:9], v4 offset:2624
    ds_read_b64 a[10:11], v4 offset:2632
    ds_read_b128 a[56:59], v5 offset:3136
    ds_read_b64 a[4:5], v4 offset:3136
    ds_read_b64 a[6:7], v4 offset:3144
    ds_read_b128 a[60:63], v5 offset:3648
    ds_read_b64 a[0:1], v4 offset:3648
    ds_read_b64 a[2:3], v4 offset:3656
L5_cvl:
    s_waitcnt lgkmcnt(0)
    v_mfma_f32_16x16x32_bf16 v[36:39], a[28:31], a[32:35], v[36:39]
    ds_read_b128 a[96:99], v5 offset:0
    v_mfma_f32_16x16x32_bf16 v[32:35], a[24:27], a[32:35], v[32:35]
    ds_read_b64 a[92:93], v4 offset:0
    v_mfma_f32_16x16x32_bf16 v[36:39], a[24:27], a[36:39], v[36:39]
    ds_read_b64 a[94:95], v4 offset:8
    v_mfma_f32_16x16x32_bf16 v[28:31], a[20:23], a[32:35], v[28:31]
    ds_read_b128 a[100:103], v5 offset:512
    v_mfma_f32_16x16x32_bf16 v[32:35], a[20:23], a[36:39], v[32:35]
    ds_read_b64 a[88:89], v4 offset:512
    v_mfma_f32_16x16x32_bf16 v[36:39], a[20:23], a[40:43], v[36:39]
    ds_read_b64 a[90:91], v4 offset:520
    v_mfma_f32_16x16x32_bf16 v[24:27], a[16:19], a[32:35], v[24:27]
    ds_read_b128 a[104:107], v5 offset:1024
    v_mfma_f32_16x16x32_bf16 v[28:31], a[16:19], a[36:39], v[28:31]
    ds_read_b64 a[84:85], v4 offset:1024
    v_mfma_f32_16x16x32_bf16 v[32:35], a[16:19], a[40:43], v[32:35]
    ds_read_b64 a[86:87], v4 offset:1032
    v_mfma_f32_16x16x32_bf16 v[36:39], a[16:19], a[44:47], v[36:39]
    ds_read_b128 a[108:111], v5 offset:1536
    v_mfma_f32_16x16x32_bf16 v[20:23], a[12:15], a[32:35], v[20:23]
    ds_read_b64 a[80:81], v4 offset:1536
    v_mfma_f32_16x16x32_bf16 v[24:27], a[12:15], a[36:39], v[24:27]
    ds_read_b64 a[82:83], v4 offset:1544
    v_mfma_f32_16x16x32_bf16 v[28:31], a[12:15], a[40:43], v[28:31]
    ds_read_b128 a[112:115], v5 offset:2048
    v_mfma_f32_16x16x32_bf16 v[32:35], a[12:15], a[44:47], v[32:35]
    ds_read_b64 a[76:77], v4 offset:2048
    v_mfma_f32_16x16x32_bf16 v[36:39], a[12:15], a[48:51], v[36:39]
    ds_read_b64 a[78:79], v4 offset:2056
    v_mfma_f32_16x16x32_bf16 v[16:19], a[8:11], a[32:35], v[16:19]
    ds_read_b128 a[116:119], v5 offset:2560
    v_mfma_f32_16x16x32_bf16 v[20:23], a[8:11], a[36:39], v[20:23]
    ds_read_b64 a[72:73], v4 offset:2560
    v_mfma_f32_16x16x32_bf16 v[24:27], a[8:11], a[40:43], v[24:27]
    ds_read_b64 a[74:75], v4 offset:2568
    v_mfma_f32_16x16x32_bf16 v[28:31], a[8:11], a[44:47], v[28:31]
    ds_read_b128 a[120:123], v5 offset:3072
    v_mfma_f32_16x16x32_bf16 v[32:35], a[8:11], a[48:51], v[32:35]
    ds_read_b64 a[68:69], v4 offset:3072
    v_mfma_f32_16x16x32_bf16 v[36:39], a[8:11], a[52:55], v[36:39]
    ds_read_b64 a[70:71], v4 offset:3080
    v_mfma_f32_16x16x32_bf16 v[12:15], a[4:7], a[32:35], v[12:15]
    ds_read_b128 a[124:127], v5 offset:3584
    v_mfma_f32_16x16x32_bf16 v[16:19], a[4:7], a[36:39], v[16:19]
    ds_read_b64 a[64:65], v4 offset:3584
    v_mfma_f32_16x16x32_bf16 v[20:23], a[4:7], a[40:43], v[20:23]
    ds_read_b64 a[66:67], v4 offset:3592
    v_mfma_f32_16x16x32_bf16 v[24:27], a[4:7], a[44:47], v[24:27]
    ds_read_b128 v[40:43], v6 offset:3584
    v_mfma_f32_16x16x32_bf16 v[28:31], a[4:7], a[48:51], v[28:31]
    ds_read_b128 v[44:47], v6 offset:3072
    v_mfma_f32_16x16x32_bf16 v[32:35], a[4:7], a[52:55], v[32:35]
    ds_read_b128 v[48:51], v6 offset:2560
    v_mfma_f32_16x16x32_bf16 v[36:39], a[4:7], a[56:59], v[36:39]
    ds_read_b128 v[52:55], v6 offset:2048
    v_mfma_f32_16x16x32_bf16 v[8:11], a[0:3], a[32:35], v[8:11]
    ds_read_b128 v[56:59], v6 offset:1536
    v_mfma_f32_16x16x32_bf16 v[12:15], a[0:3], a[36:39], v[12:15]
    ds_read_b128 v[60:63], v6 offset:1024
    v_mfma_f32_16x16x32_bf16 v[16:19], a[0:3], a[40:43], v[16:19]
    ds_read_b128 v[64:67], v6 offset:512
    v_mfma_f32_16x16x32_bf16 v[20:23], a[0:3], a[44:47], v[20:23]
    ds_read_b128 v[68:71], v6 offset:0
    v_mfma_f32_16x16x32_bf16 v[24:27], a[0:3], a[48:51], v[24:27]
    v_mfma_f32_16x16x32_bf16 v[28:31], a[0:3], a[52:55], v[28:31]
    v_mfma_f32_16x16x32_bf16 v[32:35], a[0:3], a[56:59], v[32:35]
    v_mfma_f32_16x16x32_bf16 v[36:39], a[0:3], a[60:63], v[36:39]
    s_cmp_eq_u32 s38, 3
    s_cbranch_scc1 L5_cvx
    s_add_u32 s38, s38, 1
    s_waitcnt lgkmcnt(0)
    v_mfma_f32_16x16x32_bf16 v[36:39], a[92:95], a[96:99], v[36:39]
    v_subrev_u32 v4, 128, v4
    v_mfma_f32_16x16x32_bf16 v[32:35], a[88:91], a[96:99], v[32:35]
    v_subrev_u32 v5, 128, v5
    v_mfma_f32_16x16x32_bf16 v[36:39], a[88:91], a[100:103], v[36:39]
    ds_read_b128 a[32:35], v5 offset:64
    v_mfma_f32_16x16x32_bf16 v[28:31], a[84:87], a[96:99], v[28:31]
    ds_read_b64 a[28:29], v4 offset:64
    v_mfma_f32_16x16x32_bf16 v[32:35], a[84:87], a[100:103], v[32:35]
    ds_read_b64 a[30:31], v4 offset:72
    v_mfma_f32_16x16x32_bf16 v[36:39], a[84:87], a[104:107], v[36:39]
    ds_read_b128 a[36:39], v5 offset:576
    v_mfma_f32_16x16x32_bf16 v[24:27], a[80:83], a[96:99], v[24:27]
    ds_read_b64 a[24:25], v4 offset:576
    v_mfma_f32_16x16x32_bf16 v[28:31], a[80:83], a[100:103], v[28:31]
    ds_read_b64 a[26:27], v4 offset:584
    v_mfma_f32_16x16x32_bf16 v[32:35], a[80:83], a[104:107], v[32:35]
    ds_read_b128 a[40:43], v5 offset:1088
    v_mfma_f32_16x16x32_bf16 v[36:39], a[80:83], a[108:111], v[36:39]
    ds_read_b64 a[20:21], v4 offset:1088
    v_mfma_f32_16x16x32_bf16 v[20:23], a[76:79], a[96:99], v[20:23]
    ds_read_b64 a[22:23], v4 offset:1096
    v_mfma_f32_16x16x32_bf16 v[24:27], a[76:79], a[100:103], v[24:27]
    ds_read_b128 a[44:47], v5 offset:1600
    v_mfma_f32_16x16x32_bf16 v[28:31], a[76:79], a[104:107], v[28:31]
    ds_read_b64 a[16:17], v4 offset:1600
    v_mfma_f32_16x16x32_bf16 v[32:35], a[76:79], a[108:111], v[32:35]
    ds_read_b64 a[18:19], v4 offset:1608
    v_mfma_f32_16x16x32_bf16 v[36:39], a[76:79], a[112:115], v[36:39]
    ds_read_b128 a[48:51], v5 offset:2112
    v_mfma_f32_16x16x32_bf16 v[16:19], a[72:75], a[96:99], v[16:19]
    ds_read_b64 a[12:13], v4 offset:2112
    v_mfma_f32_16x16x32_bf16 v[20:23], a[72:75], a[100:103], v[20:23]
    ds_read_b64 a[14:15], v4 offset:2120
    v_mfma_f32_16x16x32_bf16 v[24:27], a[72:75], a[104:107], v[24:27]
    ds_read_b128 a[52:55], v5 offset:2624
    v_mfma_f32_16x16x32_bf16 v[28:31], a[72:75], a[108:111], v[28:31]
    ds_read_b64 a[8:9], v4 offset:2624
    v_mfma_f32_16x16x32_bf16 v[32:35], a[72:75], a[112:115], v[32:35]
    ds_read_b64 a[10:11], v4 offset:2632
    v_mfma_f32_16x16x32_bf16 v[36:39], a[72:75], a[116:119], v[36:39]
    ds_read_b128 a[56:59], v5 offset:3136
    v_mfma_f32_16x16x32_bf16 v[12:15], a[68:71], a[96:99], v[12:15]
    ds_read_b64 a[4:5], v4 offset:3136
    v_mfma_f32_16x16x32_bf16 v[16:19], a[68:71], a[100:103], v[16:19]
    ds_read_b64 a[6:7], v4 offset:3144
    v_mfma_f32_16x16x32_bf16 v[20:23], a[68:71], a[104:107], v[20:23]
    ds_read_b128 a[60:63], v5 offset:3648
    v_mfma_f32_16x16x32_bf16 v[24:27], a[68:71], a[108:111], v[24:27]
    ds_read_b64 a[0:1], v4 offset:3648
    v_mfma_f32_16x16x32_bf16 v[28:31], a[68:71], a[112:115], v[28:31]
    ds_read_b64 a[2:3], v4 offset:3656
    v_mfma_f32_16x16x32_bf16 v[32:35], a[68:71], a[116:119], v[32:35]
    v_mfma_f32_16x16x32_bf16 v[36:39], a[68:71], a[120:123], v[36:39]
    v_mfma_f32_16x16x32_bf16 v[8:11], a[64:67], a[96:99], v[8:11]
    v_mfma_f32_16x16x32_bf16 v[12:15], a[64:67], a[100:103], v[12:15]
    v_mfma_f32_16x16x32_bf16 v[16:19], a[64:67], a[104:107], v[16:19]
    v_mfma_f32_16x16x32_bf16 v[20:23], a[64:67], a[108:111], v[20:23]
    v_mfma_f32_16x16x32_bf16 v[24:27], a[64:67], a[112:115], v[24:27]
    v_mfma_f32_16x16x32_bf16 v[28:31], a[64:67], a[116:119], v[28:31]
    v_mfma_f32_16x16x32_bf16 v[32:35], a[64:67], a[120:123], v[32:35]
    v_mfma_f32_16x16x32_bf16 v[36:39], a[64:67], a[124:127], v[36:39]
    s_branch L5_cvl
L5_cvx:
    s_waitcnt lgkmcnt(0)
    v_mfma_f32_16x16x32_bf16 v[8:11], a[64:67], a[96:99], v[8:11]
    v_mov_b32 v108, 1
    s_mov_b64 exec, 1
    ds_add_u32 v1, v108 offset:12
    s_mov_b64 exec, -1
    v_dot2_f32_bf16 v72, v43, v110, 0
    v_dot2_f32_bf16 v73, v42, v110, 0
    v_mfma_f32_16x16x32_bf16 v[12:15], a[68:71], a[96:99], v[12:15]
    v_dot2_f32_bf16 v74, v41, v110, 0
    v_dot2_f32_bf16 v75, v40, v110, 0
    v_dot2_f32_bf16 v76, v47, v110, 0
    v_mfma_f32_16x16x32_bf16 v[12:15], a[64:67], a[100:103], v[12:15]
    v_dot2_f32_bf16 v77, v46, v110, 0
    v_dot2_f32_bf16 v78, v45, v110, 0
    v_dot2_f32_bf16 v79, v44, v110, 0
    v_mfma_f32_16x16x32_bf16 v[16:19], a[72:75], a[96:99], v[16:19]
    v_dot2_f32_bf16 v80, v51, v110, 0
    v_dot2_f32_bf16 v81, v50, v110, 0
    v_dot2_f32_bf16 v82, v49, v110, 0
    v_mfma_f32_16x16x32_bf16 v[16:19], a[68:71], a[100:103], v[16:19]
    v_dot2_f32_bf16 v83, v48, v110, 0
    v_dot2_f32_bf16 v84, v55, v110, 0
    v_dot2_f32_bf16 v85, v54, v110, 0
    v_mfma_f32_16x16x32_bf16 v[16:19], a[64:67], a[104:107], v[16:19]
    v_dot2_f32_bf16 v86, v53, v110, 0
    v_dot2_f32_bf16 v87, v52, v110, 0
    v_cvt_pk_bf16_f32 v72, v8, v72
    v_mfma_f32_16x16x32_bf16 v[20:23], a[76:79], a[96:99], v[20:23]
    v_cvt_pk_bf16_f32 v73, v9, v73
    v_cvt_pk_bf16_f32 v74, v10, v74
    v_cvt_pk_bf16_f32 v75, v11, v75
    v_mfma_f32_16x16x32_bf16 v[20:23], a[72:75], a[100:103], v[20:23]
    v_dot2_f32_bf16 v72, v72, s36, 0
    v_dot2_f32_bf16 v73, v73, s36, 0
    v_dot2_f32_bf16 v74, v74, s36, 0
    v_mfma_f32_16x16x32_bf16 v[20:23], a[68:71], a[104:107], v[20:23]
    v_dot2_f32_bf16 v75, v75, s36, 0
    v_cvt_pk_bf16_f32 v72, v72, v73
    s_nop 1
    v_cvt_pk_bf16_f32 v73, v74, v75
    v_mfma_f32_16x16x32_bf16 v[20:23], a[64:67], a[108:111], v[20:23]
    buffer_store_dwordx2 v[72:73], v7, s[4:7], s37 offen sc1
    s_add_u32 s37, s37, 294912
    v_cvt_pk_bf16_f32 v76, v12, v76
    v_mfma_f32_16x16x32_bf16 v[24:27], a[80:83], a[96:99], v[24:27]
    v_cvt_pk_bf16_f32 v77, v13, v77
    v_cvt_pk_bf16_f32 v78, v14, v78
    v_cvt_pk_bf16_f32 v79, v15, v79
    v_mfma_f32_16x16x32_bf16 v[24:27], a[76:79], a[100:103], v[24:27]
    v_dot2_f32_bf16 v76, v76, s36, 0
    v_dot2_f32_bf16 v77, v77, s36, 0
    v_dot2_f32_bf16 v78, v78, s36, 0
    v_mfma_f32_16x16x32_bf16 v[24:27], a[72:75], a[104:107], v[24:27]
    v_dot2_f32_bf16 v79, v79, s36, 0
    v_cvt_pk_bf16_f32 v76, v76, v77
    s_nop 1
    v_cvt_pk_bf16_f32 v77, v78, v79
    v_mfma_f32_16x16x32_bf16 v[24:27], a[68:71], a[108:111], v[24:27]
    buffer_store_dwordx2 v[76:77], v7, s[4:7], s37 offen sc1
    s_add_u32 s37, s37, 294912
    v_dot2_f32_bf16 v88, v59, v110, 0
    v_mfma_f32_16x16x32_bf16 v[24:27], a[64:67], a[112:115], v[24:27]
    v_dot2_f32_bf16 v89, v58, v110, 0
    v_dot2_f32_bf16 v90, v57, v110, 0
    v_dot2_f32_bf16 v91, v56, v110, 0
    v_mfma_f32_16x16x32_bf16 v[28:31], a[84:87], a[96:99], v[28:31]
    v_dot2_f32_bf16 v92, v63, v110, 0
    v_dot2_f32_bf16 v93, v62, v110, 0
    v_dot2_f32_bf16 v94, v61, v110, 0
    v_mfma_f32_16x16x32_bf16 v[28:31], a[80:83], a[100:103], v[28:31]
    v_dot2_f32_bf16 v95, v60, v110, 0
    v_cvt_pk_bf16_f32 v80, v16, v80
    v_cvt_pk_bf16_f32 v81, v17, v81
    v_mfma_f32_16x16x32_bf16 v[28:31], a[76:79], a[104:107], v[28:31]
    v_cvt_pk_bf16_f32 v82, v18, v82
    v_cvt_pk_bf16_f32 v83, v19, v83
    v_dot2_f32_bf16 v80, v80, s36, 0
    v_mfma_f32_16x16x32_bf16 v[28:31], a[72:75], a[108:111], v[28:31]
    v_dot2_f32_bf16 v81, v81, s36, 0
    v_dot2_f32_bf16 v82, v82, s36, 0
    v_dot2_f32_bf16 v83, v83, s36, 0
    v_mfma_f32_16x16x32_bf16 v[28:31], a[68:71], a[112:115], v[28:31]
    v_cvt_pk_bf16_f32 v80, v80, v81
    s_nop 0
    v_cvt_pk_bf16_f32 v81, v82, v83
    buffer_store_dwordx2 v[80:81], v7, s[4:7], s37 offen sc1
    v_mfma_f32_16x16x32_bf16 v[28:31], a[64:67], a[116:119], v[28:31]
    s_add_u32 s37, s37, 294912
    v_dot2_f32_bf16 v96, v67, v110, 0
    v_dot2_f32_bf16 v97, v66, v110, 0
    v_mfma_f32_16x16x32_bf16 v[32:35], a[88:91], a[96:99], v[32:35]
    v_dot2_f32_bf16 v98, v65, v110, 0
    v_dot2_f32_bf16 v99, v64, v110, 0
    v_dot2_f32_bf16 v100, v71, v110, 0
    v_mfma_f32_16x16x32_bf16 v[32:35], a[84:87], a[100:103], v[32:35]
    v_dot2_f32_bf16 v101, v70, v110, 0
    v_dot2_f32_bf16 v102, v69, v110, 0
    v_dot2_f32_bf16 v103, v68, v110, 0
    v_mfma_f32_16x16x32_bf16 v[32:35], a[80:83], a[104:107], v[32:35]
    v_cvt_pk_bf16_f32 v84, v20, v84
    v_cvt_pk_bf16_f32 v85, v21, v85
    v_cvt_pk_bf16_f32 v86, v22, v86
    v_mfma_f32_16x16x32_bf16 v[32:35], a[76:79], a[108:111], v[32:35]
    v_cvt_pk_bf16_f32 v87, v23, v87
    v_dot2_f32_bf16 v84, v84, s36, 0
    v_dot2_f32_bf16 v85, v85, s36, 0
    v_mfma_f32_16x16x32_bf16 v[32:35], a[72:75], a[112:115], v[32:35]
    v_dot2_f32_bf16 v86, v86, s36, 0
    v_dot2_f32_bf16 v87, v87, s36, 0
    v_cvt_pk_bf16_f32 v84, v84, v85
    v_mfma_f32_16x16x32_bf16 v[32:35], a[68:71], a[116:119], v[32:35]
    s_nop 0
    v_cvt_pk_bf16_f32 v85, v86, v87
    buffer_store_dwordx2 v[84:85], v7, s[4:7], s37 offen sc1
    s_add_u32 s37, s37, 294912
    v_mfma_f32_16x16x32_bf16 v[32:35], a[64:67], a[120:123], v[32:35]
    v_cvt_pk_bf16_f32 v88, v24, v88
    v_cvt_pk_bf16_f32 v89, v25, v89
    v_cvt_pk_bf16_f32 v90, v26, v90
    v_mfma_f32_16x16x32_bf16 v[36:39], a[92:95], a[96:99], v[36:39]
    v_cvt_pk_bf16_f32 v91, v27, v91
    v_dot2_f32_bf16 v88, v88, s36, 0
    v_dot2_f32_bf16 v89, v89, s36, 0
    v_mfma_f32_16x16x32_bf16 v[36:39], a[88:91], a[100:103], v[36:39]
    v_dot2_f32_bf16 v90, v90, s36, 0
    v_dot2_f32_bf16 v91, v91, s36, 0
    v_cvt_pk_bf16_f32 v88, v88, v89
    v_mfma_f32_16x16x32_bf16 v[36:39], a[84:87], a[104:107], v[36:39]
    s_nop 0
    v_cvt_pk_bf16_f32 v89, v90, v91
    buffer_store_dwordx2 v[88:89], v7, s[4:7], s37 offen sc1
    s_add_u32 s37, s37, 294912
    v_mfma_f32_16x16x32_bf16 v[36:39], a[80:83], a[108:111], v[36:39]
    v_cvt_pk_bf16_f32 v92, v28, v92
    v_cvt_pk_bf16_f32 v93, v29, v93
    v_cvt_pk_bf16_f32 v94, v30, v94
    v_mfma_f32_16x16x32_bf16 v[36:39], a[76:79], a[112:115], v[36:39]
    v_cvt_pk_bf16_f32 v95, v31, v95
    v_dot2_f32_bf16 v92, v92, s36, 0
    v_dot2_f32_bf16 v93, v93, s36, 0
    v_mfma_f32_16x16x32_bf16 v[36:39], a[72:75], a[116:119], v[36:39]
    v_dot2_f32_bf16 v94, v94, s36, 0
    v_dot2_f32_bf16 v95, v95, s36, 0
    v_cvt_pk_bf16_f32 v92, v92, v93
    v_mfma_f32_16x16x32_bf16 v[36:39], a[68:71], a[120:123], v[36:39]
    s_nop 0
    v_cvt_pk_bf16_f32 v93, v94, v95
    buffer_store_dwordx2 v[92:93], v7, s[4:7], s37 offen sc1
    s_add_u32 s37, s37, 294912
    v_mfma_f32_16x16x32_bf16 v[36:39], a[64:67], a[124:127], v[36:39]
    v_cvt_pk_bf16_f32 v96, v32, v96
    v_cvt_pk_bf16_f32 v97, v33, v97
    v_cvt_pk_bf16_f32 v98, v34, v98
    v_cvt_pk_bf16_f32 v99, v35, v99
    v_dot2_f32_bf16 v96, v96, s36, 0
    v_dot2_f32_bf16 v97, v97, s36, 0
    v_dot2_f32_bf16 v98, v98, s36, 0
    v_dot2_f32_bf16 v99, v99, s36, 0
    s_nop 0
    v_cvt_pk_bf16_f32 v96, v96, v97
    s_nop 0
    v_cvt_pk_bf16_f32 v97, v98, v99
    buffer_store_dwordx2 v[96:97], v7, s[4:7], s37 offen sc1
    s_add_u32 s37, s37, 294912
    v_cvt_pk_bf16_f32 v100, v36, v100
    v_cvt_pk_bf16_f32 v101, v37, v101
    v_cvt_pk_bf16_f32 v102, v38, v102
    v_cvt_pk_bf16_f32 v103, v39, v103
    v_dot2_f32_bf16 v100, v100, s36, 0
    v_dot2_f32_bf16 v101, v101, s36, 0
    v_dot2_f32_bf16 v102, v102, s36, 0
    v_dot2_f32_bf16 v103, v103, s36, 0
    s_nop 0
    v_cvt_pk_bf16_f32 v100, v100, v101
    s_nop 0
    v_cvt_pk_bf16_f32 v101, v102, v103
    buffer_store_dwordx2 v[100:101], v7, s[4:7], s37 offen sc1
L5_aux:
L_tok15:
    ds_read_b64 v[8:9], v1
    s_waitcnt lgkmcnt(0)
    v_readfirstlane_b32 s40, v8
    v_readfirstlane_b32 s41, v9
    s_cmp_eq_u32 s40, 2
    s_cbranch_scc1 L5_fallback
    s_cmp_eq_u32 s40, 1
    s_cbranch_scc1 L_tokx16
    s_cmp_eq_u32 s28, 0
    s_cbranch_scc1 L_tokx16
    s_sub_u32 s28, s28, 1
    s_sleep 1
    s_branch L_tok15
L_tokx16:
    s_mov_b32 s8, s64
    s_mov_b32 s9, s65
    s_mov_b32 s10, 2359296
    s_mov_b32 s11, 0x00020000
    s_mov_b32 s32, 0
    s_mov_b32 s37, 0
    s_cmp_eq_u32 s31, 3
    s_cselect_b32 s18, 3, 2
    s_cmp_eq_u32 s31, 0
    s_cselect_b32 s18, 6, s18
    s_mov_b32 s19, 0
    s_mov_b32 s48, 0x3f803f80
    s_mov_b32 s49, 0x01010101
    s_mov_b32 s50, -1
    s_mov_b32 s51, 0
    s_mov_b32 s52, 0xffff0000
    s_mov_b32 s53, 0xffff0000
    s_mov_b32 s54, 0x11111111
    s_mov_b32 s55, 0x11111111
    s_mov_b32 s56, 0x33333333
    s_mov_b32 s57, 0x33333333
    s_mov_b32 s58, 0x77777777
    s_mov_b32 s59, 0x77777777
    s_mov_b32 s60, 0xf0f0f0f0
    s_mov_b32 s61, 0xf0f0f0f0
    s_mov_b32 s62, 0xaaaaaaaa
    s_mov_b32 s63, 0xaaaaaaaa
    s_lshl_b32 s40, s30, 3
    s_lshl_b32 s41, s31, 1
    s_add_u32 s40, s40, s41
    s_add_u32 s35, s40, s25
    s_mul_i32 s33, s40, 18432
    s_add_u32 s33, s33, s26
    s_sub_u32 s38, 6, s41
    s_lshl_b32 s40, s30, 8
    s_lshl_b32 s41, s38, 5
    s_add_u32 s34, s40, s41
    s_add_u32 s34, s34, s27
    s_add_u32 s34, s34, 256
    s_lshl_b32 s40, s20, 4
    s_add_u32 s40, s40, s35
    s_mul_i32 s36, s40, 18432
    s_mul_i32 s41, s24, 144
    s_add_u32 s36, s36, s41
    s_lshl_b32 s40, s23, 4
    s_add_u32 s40, s40, s22
    s_lshl_b32 s40, s40, 12
    s_add_u32 s15, s40, 17825792
    s_lshl_b32 s40, s35, 11
    s_add_u32 s16, s40, s26
    s_add_u32 s16, s16, 294912
    s_lshl_b32 s40, s23, 1
    s_add_u32 s40, s40, s25
    s_lshl_b32 s40, s40, 3
    s_add_u32 s40, s40, s24
    s_mul_i32 s17, s40, 9216
    s_lshl_b32 s41, s31, 5
    s_add_u32 s17, s17, s41
    s_add_u32 s17, s17, 5242880
    v_and_b32 v4, 7, v2
    v_bfe_u32 v5, v2, 3, 1
    v_lshl_add_u32 v4, v4, 1, v5
    v_mul_u32_u24 v4, 1152, v4
    v_lshrrev_b32 v5, 4, v2
    v_lshl_add_u32 v110, v5, 3, v4
    v_mov_b32 v108, 0
    v_mov_b32 v109, 0
    v_lshlrev_b32 v79, 7, v2
    s_lshl_b32 s42, s24, 12
    s_add_u32 s42, s42, 19992576
    v_add_u32 v79, s42, v79
    v_mov_b32 v78, 0
    buffer_load_dwordx2 v[100:101], v110, s[8:11], s36 offen offset:0
    buffer_load_dwordx2 v[102:103], v110, s[8:11], s36 offen offset:32
    buffer_load_dwordx2 v[104:105], v110, s[8:11], s36 offen offset:64
    buffer_load_dwordx2 v[106:107], v110, s[8:11], s36 offen offset:96
    s_mov_b64 exec, s[50:51]
    buffer_load_dwordx2 v[108:109], v110, s[8:11], s36 offen offset:128
    s_mov_b64 exec, -1
    v_mov_b32 v80, 0
    v_mov_b32 v81, 0
    v_mov_b32 v82, 0
    v_mov_b32 v83, 0
    v_mov_b32 v84, 0
    v_mov_b32 v85, 0
    v_mov_b32 v86, 0
    v_mov_b32 v87, 0
    v_mov_b32 v88, 0
    v_mov_b32 v89, 0
    v_mov_b32 v90, 0
    v_mov_b32 v91, 0
    v_mov_b32 v92, 0
    v_mov_b32 v93, 0
    v_mov_b32 v94, 0
    v_mov_b32 v95, 0
    v_mov_b32 v96, 0
    v_mov_b32 v97, 0
    v_mov_b32 v98, 0
    v_mov_b32 v99, 0
    s_mov_b32 s8, s82
    s_mov_b32 s9, s83
    s_mov_b32 s10, 2359296
    s_mov_b32 s11, 0x00020000
    s_mov_b32 s39, 0
    s_cmp_ge_u32 s21, 24
    s_cbranch_scc1 L5_aw
    s_cmp_eq_u32 s31, 3
    s_cselect_b32 s39, 1, 0
    s_cbranch_scc1 L5_al
    v_mov_b32 v8, 1
    s_waitcnt vmcnt(5)
    s_mov_b64 exec, 1
    ds_add_rtn_u32 v9, v1, v8 offset:28
    s_mov_b64 exec, -1
    s_lshl_b32 s40, s20, 12
    s_lshl_b32 s41, s21, 7
    s_add_u32 s40, s40, s41
    s_add_u32 s40, s40, 19992576
    s_waitcnt lgkmcnt(0)
    v_readfirstlane_b32 s41, v9
    s_nop 0
    s_cmp_lg_u32 s41, 2
    s_cbranch_scc1 L_cf17
    v_mov_b32 v8, 0
    v_mov_b32 v9, s94
    s_mov_b64 exec, 1
    buffer_store_dword v9, v8, s[4:7], s40 offen offset:0 sc1
    s_mov_b64 exec, -1
L_cf17:
    s_branch L5_al
L5_aw:
    s_cmp_eq_u32 s31, 3
    s_cbranch_scc1 L5_al
    s_cmp_lt_u32 s21, 24
    s_cselect_b32 s42, 4, 1
L_lw18:
    ds_read_b32 v8, v1 offset:12
    s_waitcnt lgkmcnt(0)
    v_readfirstlane_b32 s40, v8
    s_nop 0
    s_cmp_ge_u32 s40, s42
    s_cbranch_scc1 L_lwx19
    s_cmp_eq_u32 s28, 0
    s_cbranch_scc1 L_lwx19
    s_sub_u32 s28, s28, 1
    s_branch L_lw18
L_lwx19:
L_lw20:
    ds_read_b32 v8, v1 offset:44
    s_waitcnt lgkmcnt(0)
    v_readfirstlane_b32 s40, v8
    s_nop 0
    s_cmp_ge_u32 s40, 4
    s_cbranch_scc1 L_lwx21
    s_cmp_eq_u32 s28, 0
    s_cbranch_scc1 L_lwx21
    s_sub_u32 s28, s28, 1
    s_sleep 2
    s_branch L_lw20
L_lwx21:
    s_mul_i32 s40, s24, 82944
    s_mul_i32 s41, s31, 27648
    s_add_u32 s40, s40, s41
    s_add_u32 s40, s40, 24117248
    s_mov_b32 m0, s41
    s_nop 0
    buffer_load_dwordx4 v3, s[4:7], s40 offen offset:0 sc1 lds
    buffer_load_dwordx4 v3, s[4:7], s40 offen offset:1024 sc1 lds
    buffer_load_dwordx4 v3, s[4:7], s40 offen offset:2048 sc1 lds
    buffer_load_dwordx4 v3, s[4:7], s40 offen offset:3072 sc1 lds
    s_add_u32 s41, s41, 4096
    s_add_u32 s40, s40, 4096
    s_mov_b32 m0, s41
    s_nop 0
    buffer_load_dwordx4 v3, s[4:7], s40 offen offset:0 sc1 lds
    buffer_load_dwordx4 v3, s[4:7], s40 offen offset:1024 sc1 lds
    buffer_load_dwordx4 v3, s[4:7], s40 offen offset:2048 sc1 lds
    buffer_load_dwordx4 v3, s[4:7], s40 offen offset:3072 sc1 lds
    s_add_u32 s41, s41, 4096
    s_add_u32 s40, s40, 4096
    s_mov_b32 m0, s41
    s_nop 0
    buffer_load_dwordx4 v3, s[4:7], s40 offen offset:0 sc1 lds
    buffer_load_dwordx4 v3, s[4:7], s40 offen offset:1024 sc1 lds
    buffer_load_dwordx4 v3, s[4:7], s40 offen offset:2048 sc1 lds
    buffer_load_dwordx4 v3, s[4:7], s40 offen offset:3072 sc1 lds
    s_add_u32 s41, s41, 4096
    s_add_u32 s40, s40, 4096
    s_mov_b32 m0, s41
    s_nop 0
    buffer_load_dwordx4 v3, s[4:7], s40 offen offset:0 sc1 lds
    buffer_load_dwordx4 v3, s[4:7], s40 offen offset:1024 sc1 lds
    buffer_load_dwordx4 v3, s[4:7], s40 offen offset:2048 sc1 lds
    buffer_load_dwordx4 v3, s[4:7], s40 offen offset:3072 sc1 lds
    s_add_u32 s41, s41, 4096
    s_add_u32 s40, s40, 4096
    s_mov_b32 m0, s41
    s_nop 0
    buffer_load_dwordx4 v3, s[4:7], s40 offen offset:0 sc1 lds
    buffer_load_dwordx4 v3, s[4:7], s40 offen offset:1024 sc1 lds
    buffer_load_dwordx4 v3, s[4:7], s40 offen offset:2048 sc1 lds
    buffer_load_dwordx4 v3, s[4:7], s40 offen offset:3072 sc1 lds
    s_add_u32 s41, s41, 4096
    s_add_u32 s40, s40, 4096
    s_mov_b32 m0, s41
    s_nop 0
    buffer_load_dwordx4 v3, s[4:7], s40 offen offset:0 sc1 lds
    buffer_load_dwordx4 v3, s[4:7], s40 offen offset:1024 sc1 lds
    buffer_load_dwordx4 v3, s[4:7], s40 offen offset:2048 sc1 lds
    buffer_load_dwordx4 v3, s[4:7], s40 offen offset:3072 sc1 lds
    s_add_u32 s41, s41, 4096
    s_add_u32 s40, s40, 4096
    s_mov_b32 m0, s41
    s_nop 0
    buffer_load_dwordx4 v3, s[4:7], s40 offen offset:0 sc1 lds
    buffer_load_dwordx4 v3, s[4:7], s40 offen offset:1024 sc1 lds
    buffer_load_dwordx4 v3, s[4:7], s40 offen offset:2048 sc1 lds
    s_cmp_ge_u32 s21, 24
    s_cbranch_scc1 L5_ancf
    v_mov_b32 v8, 1
    s_waitcnt vmcnt(32)
    s_mov_b64 exec, 1
    ds_add_rtn_u32 v9, v1, v8 offset:28
    s_mov_b64 exec, -1
    s_lshl_b32 s40, s20, 12
    s_lshl_b32 s41, s21, 7
    s_add_u32 s40, s40, s41
    s_add_u32 s40, s40, 19992576
    s_waitcnt lgkmcnt(0)
    v_readfirstlane_b32 s41, v9
    s_nop 0
    s_cmp_lg_u32 s41, 2
    s_cbranch_scc1 L_cf22
    v_mov_b32 v8, 0
    v_mov_b32 v9, s94
    s_mov_b64 exec, 1
    buffer_store_dword v9, v8, s[4:7], s40 offen offset:0 sc1
    s_mov_b64 exec, -1
L_cf22:
L5_ancf:
    s_waitcnt vmcnt(0)
    v_mov_b32 v8, 1
    s_mov_b64 exec, 1
    ds_add_u32 v1, v8 offset:52
    s_mov_b64 exec, -1
L5_al:
    s_add_u32 s40, s38, 0
    s_mul_i32 s41, s40, 205
    s_lshr_b32 s41, s41, 10
    s_mul_i32 s41, s41, 5
    s_sub_u32 s40, s40, s41
    s_mul_i32 s40, s40, 3840
    s_add_u32 s12, s40, 138240
    s_add_u32 s40, s38, 1
    s_mul_i32 s41, s40, 205
    s_lshr_b32 s41, s41, 10
    s_mul_i32 s41, s41, 5
    s_sub_u32 s40, s40, s41
    s_mul_i32 s40, s40, 3840
    s_add_u32 s13, s40, 138240
    s_add_u32 s40, s38, 2
    s_mul_i32 s41, s40, 205
    s_lshr_b32 s41, s41, 10
    s_mul_i32 s41, s41, 5
    s_sub_u32 s40, s40, s41
    s_mul_i32 s40, s40, 3840
    s_add_u32 s14, s40, 138240
    v_mov_b32 v8, s12
    v_mov_b32 v9, s13
    v_mov_b32 v10, s14
    v_cndmask_b32 v11, v8, v9, s[52:53]
    v_cndmask_b32 v12, v9, v10, s[52:53]
    v_and_b32 v13, 15, v2
    v_mul_u32_u24 v13, 240, v13
    v_add_u32 v76, v11, v13
    v_add_u32 v74, v12, v13
    v_subrev_u32 v13, 960, v76
    v_add_u32 v14, 960, v74
    v_cndmask_b32 v75, v14, v13, s[60:61]
    v_and_b32 v13, 32, v2
    v_add_u32 v5, v13, v74
    v_add_u32 v6, v13, v75
    v_add_u32 v7, v13, v76
    v_and_b32 v13, 3, v2
    v_bfe_u32 v14, v2, 2, 2
    v_lshl_add_u32 v13, v13, 2, v14
    v_mul_u32_u24 v13, 240, v13
    v_add_u32 v73, v11, v13
    v_add_u32 v71, v12, v13
    v_subrev_u32 v13, 960, v73
    v_add_u32 v14, 960, v71
    v_cndmask_b32 v72, v14, v13, s[62:63]
    v_add_u32 v77, s38, v2
    v_add_u32 v77, 5, v77
    v_cmp_le_u32 vcc, 9, v77
    s_nop 1
    v_subb_co_u32 v13, vcc, v77, 0, vcc
    v_cmp_eq_u32 vcc, 8, v77
    s_nop 1
    v_cndmask_b32 v13, v13, 20, vcc
    v_lshl_add_u32 v77, v13, 2, v1
    s_sub_u32 s40, s38, s32
    s_min_u32 s41, s31, 1
    s_add_u32 s40, s40, s41
    s_add_u32 s40, s40, 57
    v_mov_b32 v13, s40
    v_lshl_add_u32 v13, v13, 2, v1
    v_and_b32 v4, 4, v2
    v_cndmask_b32 v14, 8, 0, s[52:53]
    v_add_u32 v4, v4, v14
    s_cmp_lg_u32 s31, 0
    s_cbranch_scc1 L5_nhr
    s_lshl_b32 s40, s32, 4
    s_sub_u32 s40, 384, s40
    v_add_u32 v14, s40, v1
L_bw23:
    ds_read_b32 v15, v14
    s_waitcnt lgkmcnt(0)
    v_readfirstlane_b32 s40, v15
    s_nop 0
    s_cmp_eq_u32 s40, 2
    s_cbranch_scc1 L_bwx24
    s_cmp_eq_u32 s28, 0
    s_cbranch_scc1 L_bwx24
    s_sub_u32 s28, s28, 1
    s_branch L_bw23
L_bwx24:
    s_cmp_lg_u32 s23, 0
    s_cbranch_scc1 L5_hr1
    v_mov_b32 v16, 0
    v_mov_b32 v17, 0
    v_mov_b32 v18, 0
    v_mov_b32 v19, 0
    v_add_u32 v14, s14, v3
    ds_write_b128 v14, v[16:19]
    ds_write_b128 v14, v[16:19] offset:1024
    ds_write_b128 v14, v[16:19] offset:2048
    s_mov_b32 exec_hi, 0xffff
    ds_write_b128 v14, v[16:19] offset:3072
    s_mov_b64 exec, -1
    s_branch L5_nhr
L5_hr1:
    s_sub_u32 s43, s15, 65536
    v_mov_b32 v14, 0
L_vp25:
    buffer_load_dword v15, v14, s[4:7], s43 offen offset:3968 sc1
    s_waitcnt vmcnt(0)
    v_cmp_ne_u32 vcc, s94, v15
    s_cbranch_vccz L_vpx26
    s_cmp_eq_u32 s28, 0
    s_cbranch_scc1 L_vpx26
    s_sub_u32 s28, s28, 1
    s_branch L_vp25
L_vpx26:
    s_mov_b32 m0, s14
    s_nop 0
    buffer_load_dwordx4 v3, s[4:7], s43 offen sc1 lds
    buffer_load_dwordx4 v3, s[4:7], s43 offen offset:1024 sc1 lds
    buffer_load_dwordx4 v3, s[4:7], s43 offen offset:2048 sc1 lds
    s_mov_b32 exec_hi, 0xffff
    buffer_load_dwordx4 v3, s[4:7], s43 offen offset:3072 sc1 lds
    s_mov_b64 exec, -1
    s_waitcnt vmcnt(0)
L5_nhr:
    s_cmp_lg_u32 s32, 0
    s_cbranch_scc1 L5_nyp
    s_mov_b32 exec_lo, 0xffffff
    s_mov_b32 exec_hi, 0
    buffer_load_dword v78, v79, s[4:7], 0 offen sc1
    s_mov_b64 exec, -1
L5_nyp:
L_qw27:
    ds_read_b32 v15, v13
    ds_read_b32 v16, v1 offset:12
    s_waitcnt lgkmcnt(0)
    v_readfirstlane_b32 s40, v15
    v_readfirstlane_b32 s41, v16
    s_cmp_lg_u32 s39, 1
    s_cbranch_scc1 L_qwn28
    s_cmp_lt_u32 s41, 4
    s_cbranch_scc1 L_qwn28
    s_mul_i32 s46, s24, 82944
    s_add_u32 s46, s46, 24117248
    s_mov_b32 s47, 0
L_w7i30:
    s_mov_b32 m0, s47
    s_add_u32 s47, s47, 4096
    buffer_load_dwordx4 v3, s[4:7], s46 offen offset:0 sc1 lds
    buffer_load_dwordx4 v3, s[4:7], s46 offen offset:1024 sc1 lds
    buffer_load_dwordx4 v3, s[4:7], s46 offen offset:2048 sc1 lds
    buffer_load_dwordx4 v3, s[4:7], s46 offen offset:3072 sc1 lds
    s_add_u32 s46, s46, 4096
    s_cmp_lt_u32 s47, 81920
    s_cbranch_scc1 L_w7i30
    s_mov_b32 m0, s47
    s_mov_b32 s39, 2
    buffer_load_dwordx4 v3, s[4:7], s46 offen sc1 lds
L_qwn28:
    s_cmp_eq_u32 s40, s49
    s_cbranch_scc1 L_qwx29
    s_cmp_eq_u32 s28, 0
    s_cbranch_scc1 L_qwx29
    s_sub_u32 s28, s28, 1
    s_branch L_qw27
L_qwx29:
    ds_read_b128 v[8:11], v7
    ds_read_b128 v[18:21], v5 offset:64
    ds_read_b128 v[28:31], v6 offset:64
    ds_read_b128 v[38:41], v7 offset:64
    ds_read_b128 v[12:15], v7 offset:16
    ds_read_b128 v[22:25], v5 offset:80
    ds_read_b128 v[32:35], v6 offset:80
    ds_read_b128 v[42:45], v7 offset:80
    ds_read_b64 v[16:17], v76 offset:128
    ds_read_b64 v[26:27], v74 offset:136
    ds_read_b64 v[36:37], v75 offset:136
    ds_read_b64 v[46:47], v76 offset:136
    v_lshrrev_b32 v70, 5, v2
    v_mul_u32_u24 v70, 40, v70
    v_add_u32 v5, v70, v71
    v_add_u32 v6, v70, v72
    v_add_u32 v7, v70, v73
    v_mov_b32 v74, v71
    v_mov_b32 v75, v72
    v_mov_b32 v76, v73
    s_waitcnt lgkmcnt(10)
    v_mfma_f32_4x4x4_16b_bf16 v[48:51], v[18:19], v[8:9], 0
    s_waitcnt lgkmcnt(9)
    v_mfma_f32_4x4x4_16b_bf16 v[52:55], v[28:29], v[8:9], 0
    s_waitcnt lgkmcnt(8)
    v_mfma_f32_4x4x4_16b_bf16 v[56:59], v[38:39], v[8:9], 0
    v_mfma_f32_4x4x4_16b_bf16 v[48:51], v[20:21], v[10:11], v[48:51]
    v_mfma_f32_4x4x4_16b_bf16 v[52:55], v[30:31], v[10:11], v[52:55]
    v_mfma_f32_4x4x4_16b_bf16 v[56:59], v[40:41], v[10:11], v[56:59]
    s_waitcnt lgkmcnt(6)
    v_mfma_f32_4x4x4_16b_bf16 v[48:51], v[22:23], v[12:13], v[48:51]
    s_waitcnt lgkmcnt(5)
    v_mfma_f32_4x4x4_16b_bf16 v[52:55], v[32:33], v[12:13], v[52:55]
    s_waitcnt lgkmcnt(4)
    v_mfma_f32_4x4x4_16b_bf16 v[56:59], v[42:43], v[12:13], v[56:59]
    v_mfma_f32_4x4x4_16b_bf16 v[48:51], v[24:25], v[14:15], v[48:51]
    v_mfma_f32_4x4x4_16b_bf16 v[52:55], v[34:35], v[14:15], v[52:55]
    v_mfma_f32_4x4x4_16b_bf16 v[56:59], v[44:45], v[14:15], v[56:59]
    s_waitcnt lgkmcnt(3)
    v_cndmask_b32 v16, 0, v16, s[50:51]
    v_cndmask_b32 v17, v17, 0, s[50:51]
    s_waitcnt lgkmcnt(2)
    s_nop 0
    v_mfma_f32_4x4x4_16b_bf16 v[48:51], v[26:27], v[16:17], v[48:51]
    s_waitcnt lgkmcnt(1)
    v_mfma_f32_4x4x4_16b_bf16 v[52:55], v[36:37], v[16:17], v[52:55]
    s_waitcnt lgkmcnt(0)
    v_mfma_f32_4x4x4_16b_bf16 v[56:59], v[46:47], v[16:17], v[56:59]
    ds_read_b64_tr_b16 v[18:19], v5 offset:144
    ds_read_b64_tr_b16 v[24:25], v5 offset:152
    ds_read_b64_tr_b16 v[30:31], v5 offset:160
    ds_read_b64_tr_b16 v[36:37], v5 offset:168
    ds_read_b64_tr_b16 v[42:43], v74 offset:176
    ds_read_b64_tr_b16 v[20:21], v6 offset:144
    ds_read_b64_tr_b16 v[26:27], v6 offset:152
    ds_read_b64_tr_b16 v[32:33], v6 offset:160
    ds_read_b64_tr_b16 v[38:39], v6 offset:168
    ds_read_b64_tr_b16 v[44:45], v75 offset:176
    ds_read_b64_tr_b16 v[22:23], v7 offset:144
    ds_read_b64_tr_b16 v[28:29], v7 offset:152
    ds_read_b64_tr_b16 v[34:35], v7 offset:160
    ds_read_b64_tr_b16 v[40:41], v7 offset:168
    ds_read_b64_tr_b16 v[46:47], v76 offset:176
    v_cndmask_b32 v49, v57, v49, s[54:55]
    v_cndmask_b32 v50, v58, v50, s[56:57]
    v_cndmask_b32 v51, v59, v51, s[58:59]
    v_cvt_pk_bf16_f32 v60, v49, v50
    v_lshlrev_b32 v49, 16, v60
    v_and_b32 v50, 0xffff0000, v60
    v_cvt_pk_bf16_f32 v61, v51, v52
    v_lshlrev_b32 v51, 16, v61
    v_and_b32 v52, 0xffff0000, v61
    v_cvt_pk_bf16_f32 v62, v53, v54
    v_lshlrev_b32 v53, 16, v62
    v_and_b32 v54, 0xffff0000, v62
    v_cvt_pk_bf16_f32 v63, v55, v56
    v_lshlrev_b32 v55, 16, v63
    v_and_b32 v56, 0xffff0000, v63
    v_mul_f32 v49, 0x3e715bef, v49
    v_mul_f32 v50, 0x3e715bef, v50
    v_mul_f32 v51, 0x3e715bef, v51
    v_mul_f32 v52, 0x3e715bef, v52
    v_mul_f32 v53, 0x3e715bef, v53
    v_mul_f32 v54, 0x3e715bef, v54
    v_mul_f32 v55, 0x3e715bef, v55
    v_mul_f32 v56, 0x3e715bef, v56
    v_cvt_pk_bf16_f32 v60, v49, v50
    v_lshlrev_b32 v49, 16, v60
    v_and_b32 v50, 0xffff0000, v60
    v_cvt_pk_bf16_f32 v61, v51, v52
    v_lshlrev_b32 v51, 16, v61
    v_and_b32 v52, 0xffff0000, v61
    v_cvt_pk_bf16_f32 v62, v53, v54
    v_lshlrev_b32 v53, 16, v62
    v_and_b32 v54, 0xffff0000, v62
    v_cvt_pk_bf16_f32 v63, v55, v56
    v_lshlrev_b32 v55, 16, v63
    v_and_b32 v56, 0xffff0000, v63
    s_or_b32 s40, s23, s31
    s_cmp_lg_u32 s40, 0
    s_cbranch_scc1 L_nomask31
    v_mov_b32 v60, 0xce6e0000
    v_mov_b32 v61, 9
    v_mov_b32 v62, 1
    v_cndmask_b32 v61, v61, v62, s[54:55]
    v_add_u32 v61, v61, v4
    v_cmp_le_u32 vcc, 8, v61
    s_nop 1
    v_cndmask_b32 v49, v60, v49, vcc
    v_mov_b32 v61, 10
    v_mov_b32 v62, 2
    v_cndmask_b32 v61, v61, v62, s[56:57]
    v_add_u32 v61, v61, v4
    v_cmp_le_u32 vcc, 8, v61
    s_nop 1
    v_cndmask_b32 v50, v60, v50, vcc
    v_mov_b32 v61, 11
    v_mov_b32 v62, 3
    v_cndmask_b32 v61, v61, v62, s[58:59]
    v_add_u32 v61, v61, v4
    v_cmp_le_u32 vcc, 8, v61
    s_nop 1
    v_cndmask_b32 v51, v60, v51, vcc
    v_cmp_le_u32 vcc, 4, v4
    s_nop 1
    v_cndmask_b32 v52, v60, v52, vcc
    v_cmp_le_u32 vcc, 3, v4
    s_nop 1
    v_cndmask_b32 v53, v60, v53, vcc
    v_cmp_le_u32 vcc, 2, v4
    s_nop 1
    v_cndmask_b32 v54, v60, v54, vcc
    v_cmp_le_u32 vcc, 1, v4
    s_nop 1
    v_cndmask_b32 v55, v60, v55, vcc
L_nomask31:
    s_nop 1
    v_max3_f32 v60, v49, v50, v51
    v_max3_f32 v61, v52, v53, v54
    v_max3_f32 v60, v60, v55, v56
    v_max_f32 v60, v60, v61
    v_sub_f32 v49, v49, v60
    v_sub_f32 v50, v50, v60
    v_sub_f32 v51, v51, v60
    v_sub_f32 v52, v52, v60
    v_sub_f32 v53, v53, v60
    v_sub_f32 v54, v54, v60
    v_sub_f32 v55, v55, v60
    v_sub_f32 v56, v56, v60
    v_mul_f32 v49, 0x3fb8aa3b, v49
    v_mul_f32 v50, 0x3fb8aa3b, v50
    v_mul_f32 v51, 0x3fb8aa3b, v51
    v_mul_f32 v52, 0x3fb8aa3b, v52
    v_mul_f32 v53, 0x3fb8aa3b, v53
    v_mul_f32 v54, 0x3fb8aa3b, v54
    v_mul_f32 v55, 0x3fb8aa3b, v55
    v_mul_f32 v56, 0x3fb8aa3b, v56
    v_exp_f32 v49, v49
    v_exp_f32 v50, v50
    v_exp_f32 v51, v51
    v_exp_f32 v52, v52
    v_exp_f32 v53, v53
    v_exp_f32 v54, v54
    v_exp_f32 v55, v55
    v_exp_f32 v56, v56
    v_add_f32 v60, v49, v50
    v_add_f32 v61, v51, v52
    v_add_f32 v62, v53, v54
    v_add_f32 v63, v55, v56
    v_add_f32 v60, v60, v61
    v_add_f32 v62, v62, v63
    v_add_f32 v60, v60, v62
    v_rcp_f32 v60, v60
    s_nop 0
    v_mul_f32 v49, v49, v60
    v_mul_f32 v50, v50, v60
    v_mul_f32 v51, v51, v60
    v_mul_f32 v52, v52, v60
    v_mul_f32 v53, v53, v60
    v_mul_f32 v54, v54, v60
    v_mul_f32 v55, v55, v60
    v_mul_f32 v56, v56, v60
    v_cndmask_b32 v57, v49, 0, s[54:55]
    v_cndmask_b32 v49, 0, v49, s[54:55]
    v_cndmask_b32 v58, v50, 0, s[56:57]
    v_cndmask_b32 v50, 0, v50, s[56:57]
    v_cndmask_b32 v59, v51, 0, s[58:59]
    v_cndmask_b32 v51, 0, v51, s[58:59]
    v_cvt_pk_bf16_f32 v68, 0, v49
    v_cvt_pk_bf16_f32 v69, v50, v51
    v_cvt_pk_bf16_f32 v70, v52, v53
    v_cvt_pk_bf16_f32 v71, v54, v55
    v_cvt_pk_bf16_f32 v72, v56, v57
    v_cvt_pk_bf16_f32 v73, v58, v59
    s_waitcnt lgkmcnt(14)
    v_mfma_f32_4x4x4_16b_bf16 v[48:51], v[18:19], v[68:69], 0
    s_waitcnt lgkmcnt(13)
    v_mfma_f32_4x4x4_16b_bf16 v[52:55], v[24:25], v[68:69], 0
    s_waitcnt lgkmcnt(12)
    v_mfma_f32_4x4x4_16b_bf16 v[56:59], v[30:31], v[68:69], 0
    s_waitcnt lgkmcnt(11)
    v_mfma_f32_4x4x4_16b_bf16 v[60:63], v[36:37], v[68:69], 0
    s_waitcnt lgkmcnt(10)
    v_mfma_f32_4x4x4_16b_bf16 v[64:67], v[42:43], v[68:69], 0
    s_waitcnt lgkmcnt(9)
    v_mfma_f32_4x4x4_16b_bf16 v[48:51], v[20:21], v[70:71], v[48:51]
    s_waitcnt lgkmcnt(8)
    v_mfma_f32_4x4x4_16b_bf16 v[52:55], v[26:27], v[70:71], v[52:55]
    s_waitcnt lgkmcnt(7)
    v_mfma_f32_4x4x4_16b_bf16 v[56:59], v[32:33], v[70:71], v[56:59]
    s_waitcnt lgkmcnt(6)
    v_mfma_f32_4x4x4_16b_bf16 v[60:63], v[38:39], v[70:71], v[60:63]
    s_waitcnt lgkmcnt(5)
    v_mfma_f32_4x4x4_16b_bf16 v[64:67], v[44:45], v[70:71], v[64:67]
    s_waitcnt lgkmcnt(4)
    v_mfma_f32_4x4x4_16b_bf16 v[48:51], v[22:23], v[72:73], v[48:51]
    s_waitcnt lgkmcnt(3)
    v_mfma_f32_4x4x4_16b_bf16 v[52:55], v[28:29], v[72:73], v[52:55]
    s_waitcnt lgkmcnt(2)
    v_mfma_f32_4x4x4_16b_bf16 v[56:59], v[34:35], v[72:73], v[56:59]
    s_waitcnt lgkmcnt(1)
    v_mfma_f32_4x4x4_16b_bf16 v[60:63], v[40:41], v[72:73], v[60:63]
    s_waitcnt lgkmcnt(0)
    v_mfma_f32_4x4x4_16b_bf16 v[64:67], v[46:47], v[72:73], v[64:67]
    s_cmp_lg_u32 s31, 3
    s_cbranch_scc1 L5_nhs
    v_add_u32 v4, s12, v3
    ds_read_b128 v[18:21], v4
    ds_read_b128 v[22:25], v4 offset:1024
    ds_read_b128 v[26:29], v4 offset:2048
    ds_read_b128 v[30:33], v4 offset:3072
    s_waitcnt lgkmcnt(0)
    buffer_store_dwordx4 v[18:21], v3, s[4:7], s15 offen sc1
    buffer_store_dwordx4 v[22:25], v3, s[4:7], s15 offen offset:1024 sc1
    buffer_store_dwordx4 v[26:29], v3, s[4:7], s15 offen offset:2048 sc1
    s_mov_b32 exec_hi, 0xffff
    buffer_store_dwordx4 v[30:33], v3, s[4:7], s15 offen offset:3072 sc1
L5_nhs:
    s_mov_b64 exec, 7
    v_cndmask_b32 v76, 1, 2, s[18:19]
    ds_add_u32 v77, v76 offset:304
    s_mov_b64 exec, -1
    v_and_b32 v5, 15, v2
    v_lshlrev_b32 v5, 4, v5
    v_add_u32 v6, 18432, v5
    v_cndmask_b32 v5, v6, v5, s[52:53]
    v_lshrrev_b32 v7, 5, v2
    v_lshl_add_u32 v6, v7, 9, v5
    v_lshl_add_u32 v5, v7, 2, v5
    s_lshl_b32 s40, s22, 10
    s_add_u32 s43, s33, s40
    s_lshr_b32 s40, s22, 1
    s_lshl_b32 s40, s40, 8
    s_and_b32 s41, s22, 1
    s_lshl_b32 s41, s41, 3
    s_add_u32 s40, s40, s41
    s_add_u32 s44, s33, s40
    s_add_u32 s44, s44, 16384
    v_cvt_pk_bf16_f32 v8, v48, v49
    v_cvt_pk_bf16_f32 v9, v50, v51
    v_cvt_pk_bf16_f32 v10, v52, v53
    v_cvt_pk_bf16_f32 v11, v54, v55
    v_cvt_pk_bf16_f32 v12, v56, v57
    v_cvt_pk_bf16_f32 v13, v58, v59
    v_cvt_pk_bf16_f32 v14, v60, v61
    v_cvt_pk_bf16_f32 v15, v62, v63
    v_cvt_pk_bf16_f32 v16, v64, v65
    v_cvt_pk_bf16_f32 v17, v66, v67
    v_cndmask_b32 v16, v17, v16, s[50:51]
    buffer_store_dwordx4 v[8:11], v6, s[4:7], s43 offen
    buffer_store_dwordx4 v[12:15], v6, s[4:7], s43 offen offset:256
    buffer_store_dword v16, v5, s[4:7], s44 offen
    s_lshl_b32 s40, s22, 2
    s_add_u32 s45, s34, s40
    v_mov_b32 v4, v3
    v_add_u32 v5, 41472, v3
    v_lshrrev_b32 v6, 4, v2
    v_and_b32 v7, 7, v2
    v_lshl_add_u32 v6, v6, 3, v7
    v_lshlrev_b32 v6, 4, v6
    v_add_u32 v6, 4096, v6
    v_add_u32 v7, 41472, v6
    v_and_b32 v72, 15, v2
    v_lshlrev_b32 v72, 2, v72
    s_mul_i32 s42, s25, 18432
    s_add_u32 s42, s42, s33
    s_waitcnt vmcnt(0)
    v_mov_b32 v74, 0
    v_mov_b32 v75, s94
    s_mov_b64 exec, 1
    buffer_store_dword v75, v74, s[4:7], s45 offen offset:0
    s_mov_b64 exec, -1
    s_cmp_lg_u32 s31, 3
    s_cbranch_scc1 L5_nhf
    v_mov_b32 v74, 0
    v_mov_b32 v75, s94
    s_mov_b64 exec, 1
    buffer_store_dword v75, v74, s[4:7], s15 offen offset:3968 sc1
    s_mov_b64 exec, -1
L5_nhf:
    v_lshlrev_b32 v8, 16, v100
    v_and_b32 v9, 0xffff0000, v100
    v_lshlrev_b32 v10, 16, v101
    v_and_b32 v11, 0xffff0000, v101
    v_lshlrev_b32 v12, 16, v102
    v_and_b32 v13, 0xffff0000, v102
    v_lshlrev_b32 v14, 16, v103
    v_and_b32 v15, 0xffff0000, v103
    v_lshlrev_b32 v16, 16, v104
    v_and_b32 v17, 0xffff0000, v104
    v_lshlrev_b32 v18, 16, v105
    v_and_b32 v19, 0xffff0000, v105
    v_lshlrev_b32 v20, 16, v106
    v_and_b32 v21, 0xffff0000, v106
    v_lshlrev_b32 v22, 16, v107
    v_and_b32 v23, 0xffff0000, v107
    v_lshlrev_b32 v24, 16, v108
    v_and_b32 v25, 0xffff0000, v108
    v_lshlrev_b32 v26, 16, v109
    v_and_b32 v27, 0xffff0000, v109
    s_cmp_lg_u32 s32, 0
    s_cbranch_scc1 L5_p1
    v_cmp_ne_u32 vcc, s94, v78
    s_nop 0
    s_and_b32 s40, vcc_lo, 0xffffff
    s_cselect_b32 s37, 0, 1
    s_cmp_eq_u32 s39, 0
    s_cbranch_scc1 L5_pw0
    s_cmp_eq_u32 s39, 2
    s_cbranch_scc1 L5_pw1
L_lw32:
    ds_read_b32 v73, v1 offset:12
    s_waitcnt lgkmcnt(0)
    v_readfirstlane_b32 s40, v73
    s_nop 0
    s_cmp_ge_u32 s40, 4
    s_cbranch_scc1 L_lwx33
    s_cmp_eq_u32 s28, 0
    s_cbranch_scc1 L_lwx33
    s_sub_u32 s28, s28, 1
    s_branch L_lw32
L_lwx33:
    s_mul_i32 s46, s24, 82944
    s_add_u32 s46, s46, 24117248
    s_mov_b32 s47, 0
L_w7i34:
    s_mov_b32 m0, s47
    s_add_u32 s47, s47, 4096
    buffer_load_dwordx4 v3, s[4:7], s46 offen offset:0 sc1 lds
    buffer_load_dwordx4 v3, s[4:7], s46 offen offset:1024 sc1 lds
    buffer_load_dwordx4 v3, s[4:7], s46 offen offset:2048 sc1 lds
    buffer_load_dwordx4 v3, s[4:7], s46 offen offset:3072 sc1 lds
    s_add_u32 s46, s46, 4096
    s_cmp_lt_u32 s47, 81920
    s_cbranch_scc1 L_w7i34
    s_mov_b32 m0, s47
    s_mov_b32 s39, 2
    buffer_load_dwordx4 v3, s[4:7], s46 offen sc1 lds
    s_waitcnt vmcnt(0)
L5_pw1:
    v_mov_b32 v73, 3
    s_mov_b32 s39, 0
    ds_write_b32 v1, v73 offset:52
L5_pw0:
L_lw35:
    ds_read_b32 v73, v1 offset:52
    s_waitcnt lgkmcnt(0)
    v_readfirstlane_b32 s40, v73
    s_nop 0
    s_cmp_ge_u32 s40, 3
    s_cbranch_scc1 L_lwx36
    s_cmp_eq_u32 s28, 0
    s_cbranch_scc1 L_lwx36
    s_sub_u32 s28, s28, 1
    s_branch L_lw35
L_lwx36:
L5_p1:
L_vp37:
    buffer_load_dword v73, v72, s[4:7], s34 offen offset:0 sc1
    s_waitcnt vmcnt(0)
    v_cmp_ne_u32 vcc, s94, v73
    s_cbranch_vccz L_vpx38
    s_cmp_eq_u32 s28, 0
    s_cbranch_scc1 L_vpx38
    s_sub_u32 s28, s28, 1
    s_branch L_vp37
L_vpx38:
    buffer_load_dwordx4 a[0:3], v3, s[4:7], s42 offen offset:0 sc1
    buffer_load_dwordx4 a[4:7], v3, s[4:7], s42 offen offset:1024 sc1
    buffer_load_dwordx4 a[8:11], v3, s[4:7], s42 offen offset:2048 sc1
    buffer_load_dwordx4 a[12:15], v3, s[4:7], s42 offen offset:3072 sc1
    s_add_u32 s42, s42, 4096
    buffer_load_dwordx4 a[16:19], v3, s[4:7], s42 offen offset:0 sc1
    buffer_load_dwordx4 a[20:23], v3, s[4:7], s42 offen offset:1024 sc1
    buffer_load_dwordx4 a[24:27], v3, s[4:7], s42 offen offset:2048 sc1
    buffer_load_dwordx4 a[28:31], v3, s[4:7], s42 offen offset:3072 sc1
    s_add_u32 s42, s42, 4096
    buffer_load_dwordx4 a[32:35], v3, s[4:7], s42 offen offset:0 sc1
    buffer_load_dwordx4 a[36:39], v3, s[4:7], s42 offen offset:1024 sc1
    buffer_load_dwordx4 a[40:43], v3, s[4:7], s42 offen offset:2048 sc1
    buffer_load_dwordx4 a[44:47], v3, s[4:7], s42 offen offset:3072 sc1
    s_add_u32 s42, s42, 4096
    buffer_load_dwordx4 a[48:51], v3, s[4:7], s42 offen offset:0 sc1
    buffer_load_dwordx4 a[52:55], v3, s[4:7], s42 offen offset:1024 sc1
    buffer_load_dwordx4 a[56:59], v3, s[4:7], s42 offen offset:2048 sc1
    buffer_load_dwordx4 a[60:63], v3, s[4:7], s42 offen offset:3072 sc1
    s_add_u32 s42, s42, 4096
    buffer_load_dwordx4 a[64:67], v3, s[4:7], s42 offen offset:0 sc1
    buffer_load_dwordx4 a[68:71], v3, s[4:7], s42 offen offset:1024 sc1
    ds_read_b128 a[72:75], v4 offset:0
    ds_read_b128 a[76:79], v4 offset:1024
    ds_read_b128 a[80:83], v4 offset:2048
    ds_read_b128 a[84:87], v4 offset:3072
    ds_read_b128 a[88:91], v6 offset:0
    ds_read_b128 a[92:95], v4 offset:4608
    ds_read_b128 a[96:99], v4 offset:5632
    ds_read_b128 a[100:103], v4 offset:6656
    ds_read_b128 a[104:107], v4 offset:7680
    ds_read_b128 a[108:111], v6 offset:4608
    s_cmp_eq_u32 s37, 1
    s_cbranch_scc1 L5_py
    s_waitcnt vmcnt(17)
    s_waitcnt lgkmcnt(9)
    v_mfma_f32_16x16x32_bf16 v[28:31], a[72:75], a[0:3], 0
    ds_read_b128 a[72:75], v4 offset:9216
    s_waitcnt lgkmcnt(9)
    v_mfma_f32_16x16x32_bf16 v[32:35], a[76:79], a[0:3], 0
    ds_read_b128 a[76:79], v4 offset:10240
    s_waitcnt lgkmcnt(9)
    v_mfma_f32_16x16x32_bf16 v[36:39], a[80:83], a[0:3], 0
    ds_read_b128 a[80:83], v4 offset:11264
    s_waitcnt lgkmcnt(9)
    v_mfma_f32_16x16x32_bf16 v[40:43], a[84:87], a[0:3], 0
    ds_read_b128 a[84:87], v4 offset:12288
    s_waitcnt lgkmcnt(9)
    v_mfma_f32_16x16x32_bf16 v[44:47], a[88:91], a[0:3], 0
    ds_read_b128 a[88:91], v6 offset:9216
    s_waitcnt vmcnt(16)
    s_waitcnt lgkmcnt(9)
    v_mfma_f32_16x16x32_bf16 v[28:31], a[92:95], a[4:7], v[28:31]
    ds_read_b128 a[92:95], v4 offset:13824
    s_waitcnt lgkmcnt(9)
    v_mfma_f32_16x16x32_bf16 v[32:35], a[96:99], a[4:7], v[32:35]
    ds_read_b128 a[96:99], v4 offset:14848
    s_waitcnt lgkmcnt(9)
    v_mfma_f32_16x16x32_bf16 v[36:39], a[100:103], a[4:7], v[36:39]
    ds_read_b128 a[100:103], v4 offset:15872
    s_waitcnt lgkmcnt(9)
    v_mfma_f32_16x16x32_bf16 v[40:43], a[104:107], a[4:7], v[40:43]
    ds_read_b128 a[104:107], v4 offset:16896
    s_waitcnt lgkmcnt(9)
    v_mfma_f32_16x16x32_bf16 v[44:47], a[108:111], a[4:7], v[44:47]
    ds_read_b128 a[108:111], v6 offset:13824
    s_waitcnt vmcnt(15)
    s_waitcnt lgkmcnt(9)
    v_mfma_f32_16x16x32_bf16 v[28:31], a[72:75], a[8:11], v[28:31]
    ds_read_b128 a[72:75], v4 offset:18432
    s_waitcnt lgkmcnt(9)
    v_mfma_f32_16x16x32_bf16 v[32:35], a[76:79], a[8:11], v[32:35]
    ds_read_b128 a[76:79], v4 offset:19456
    s_waitcnt lgkmcnt(9)
    v_mfma_f32_16x16x32_bf16 v[36:39], a[80:83], a[8:11], v[36:39]
    ds_read_b128 a[80:83], v4 offset:20480
    s_waitcnt lgkmcnt(9)
    v_mfma_f32_16x16x32_bf16 v[40:43], a[84:87], a[8:11], v[40:43]
    ds_read_b128 a[84:87], v4 offset:21504
    s_waitcnt lgkmcnt(9)
    v_mfma_f32_16x16x32_bf16 v[44:47], a[88:91], a[8:11], v[44:47]
    ds_read_b128 a[88:91], v6 offset:18432
    s_waitcnt vmcnt(14)
    s_waitcnt lgkmcnt(9)
    v_mfma_f32_16x16x32_bf16 v[28:31], a[92:95], a[12:15], v[28:31]
    ds_read_b128 a[92:95], v4 offset:23040
    s_waitcnt lgkmcnt(9)
    v_mfma_f32_16x16x32_bf16 v[32:35], a[96:99], a[12:15], v[32:35]
    ds_read_b128 a[96:99], v4 offset:24064
    s_waitcnt lgkmcnt(9)
    v_mfma_f32_16x16x32_bf16 v[36:39], a[100:103], a[12:15], v[36:39]
    ds_read_b128 a[100:103], v4 offset:25088
    s_waitcnt lgkmcnt(9)
    v_mfma_f32_16x16x32_bf16 v[40:43], a[104:107], a[12:15], v[40:43]
    ds_read_b128 a[104:107], v4 offset:26112
    s_waitcnt lgkmcnt(9)
    v_mfma_f32_16x16x32_bf16 v[44:47], a[108:111], a[12:15], v[44:47]
    ds_read_b128 a[108:111], v6 offset:23040
    s_waitcnt vmcnt(13)
    s_waitcnt lgkmcnt(9)
    v_mfma_f32_16x16x32_bf16 v[28:31], a[72:75], a[16:19], v[28:31]
    ds_read_b128 a[72:75], v4 offset:27648
    s_waitcnt lgkmcnt(9)
    v_mfma_f32_16x16x32_bf16 v[32:35], a[76:79], a[16:19], v[32:35]
    ds_read_b128 a[76:79], v4 offset:28672
    s_waitcnt lgkmcnt(9)
    v_mfma_f32_16x16x32_bf16 v[36:39], a[80:83], a[16:19], v[36:39]
    ds_read_b128 a[80:83], v4 offset:29696
    s_waitcnt lgkmcnt(9)
    v_mfma_f32_16x16x32_bf16 v[40:43], a[84:87], a[16:19], v[40:43]
    ds_read_b128 a[84:87], v4 offset:30720
    s_waitcnt lgkmcnt(9)
    v_mfma_f32_16x16x32_bf16 v[44:47], a[88:91], a[16:19], v[44:47]
    ds_read_b128 a[88:91], v6 offset:27648
    s_waitcnt vmcnt(12)
    s_waitcnt lgkmcnt(9)
    v_mfma_f32_16x16x32_bf16 v[28:31], a[92:95], a[20:23], v[28:31]
    ds_read_b128 a[92:95], v4 offset:32256
    s_waitcnt lgkmcnt(9)
    v_mfma_f32_16x16x32_bf16 v[32:35], a[96:99], a[20:23], v[32:35]
    ds_read_b128 a[96:99], v4 offset:33280
    s_waitcnt lgkmcnt(9)
    v_mfma_f32_16x16x32_bf16 v[36:39], a[100:103], a[20:23], v[36:39]
    ds_read_b128 a[100:103], v4 offset:34304
    s_waitcnt lgkmcnt(9)
    v_mfma_f32_16x16x32_bf16 v[40:43], a[104:107], a[20:23], v[40:43]
    ds_read_b128 a[104:107], v4 offset:35328
    s_waitcnt lgkmcnt(9)
    v_mfma_f32_16x16x32_bf16 v[44:47], a[108:111], a[20:23], v[44:47]
    ds_read_b128 a[108:111], v6 offset:32256
    s_waitcnt vmcnt(11)
    s_waitcnt lgkmcnt(9)
    v_mfma_f32_16x16x32_bf16 v[28:31], a[72:75], a[24:27], v[28:31]
    ds_read_b128 a[72:75], v4 offset:36864
    s_waitcnt lgkmcnt(9)
    v_mfma_f32_16x16x32_bf16 v[32:35], a[76:79], a[24:27], v[32:35]
    ds_read_b128 a[76:79], v4 offset:37888
    s_waitcnt lgkmcnt(9)
    v_mfma_f32_16x16x32_bf16 v[36:39], a[80:83], a[24:27], v[36:39]
    ds_read_b128 a[80:83], v4 offset:38912
    s_waitcnt lgkmcnt(9)
    v_mfma_f32_16x16x32_bf16 v[40:43], a[84:87], a[24:27], v[40:43]
    ds_read_b128 a[84:87], v4 offset:39936
    s_waitcnt lgkmcnt(9)
    v_mfma_f32_16x16x32_bf16 v[44:47], a[88:91], a[24:27], v[44:47]
    ds_read_b128 a[88:91], v6 offset:36864
    s_waitcnt vmcnt(10)
    s_waitcnt lgkmcnt(9)
    v_mfma_f32_16x16x32_bf16 v[28:31], a[92:95], a[28:31], v[28:31]
    ds_read_b128 a[92:95], v5 offset:0
    s_waitcnt lgkmcnt(9)
    v_mfma_f32_16x16x32_bf16 v[32:35], a[96:99], a[28:31], v[32:35]
    ds_read_b128 a[96:99], v5 offset:1024
    s_waitcnt lgkmcnt(9)
    v_mfma_f32_16x16x32_bf16 v[36:39], a[100:103], a[28:31], v[36:39]
    ds_read_b128 a[100:103], v5 offset:2048
    s_waitcnt lgkmcnt(9)
    v_mfma_f32_16x16x32_bf16 v[40:43], a[104:107], a[28:31], v[40:43]
    ds_read_b128 a[104:107], v5 offset:3072
    s_waitcnt lgkmcnt(9)
    v_mfma_f32_16x16x32_bf16 v[44:47], a[108:111], a[28:31], v[44:47]
    ds_read_b128 a[108:111], v7 offset:0
    s_waitcnt vmcnt(9)
    s_waitcnt lgkmcnt(9)
    v_mfma_f32_16x16x32_bf16 v[28:31], a[72:75], a[32:35], v[28:31]
    ds_read_b128 a[72:75], v5 offset:4608
    s_waitcnt lgkmcnt(9)
    v_mfma_f32_16x16x32_bf16 v[32:35], a[76:79], a[32:35], v[32:35]
    ds_read_b128 a[76:79], v5 offset:5632
    s_waitcnt lgkmcnt(9)
    v_mfma_f32_16x16x32_bf16 v[36:39], a[80:83], a[32:35], v[36:39]
    ds_read_b128 a[80:83], v5 offset:6656
    s_waitcnt lgkmcnt(9)
    v_mfma_f32_16x16x32_bf16 v[40:43], a[84:87], a[32:35], v[40:43]
    ds_read_b128 a[84:87], v5 offset:7680
    s_waitcnt lgkmcnt(9)
    v_mfma_f32_16x16x32_bf16 v[44:47], a[88:91], a[32:35], v[44:47]
    ds_read_b128 a[88:91], v7 offset:4608
    s_waitcnt vmcnt(8)
    s_waitcnt lgkmcnt(9)
    v_mfma_f32_16x16x32_bf16 v[28:31], a[92:95], a[36:39], v[28:31]
    ds_read_b128 a[92:95], v5 offset:9216
    s_waitcnt lgkmcnt(9)
    v_mfma_f32_16x16x32_bf16 v[32:35], a[96:99], a[36:39], v[32:35]
    ds_read_b128 a[96:99], v5 offset:10240
    s_waitcnt lgkmcnt(9)
    v_mfma_f32_16x16x32_bf16 v[36:39], a[100:103], a[36:39], v[36:39]
    ds_read_b128 a[100:103], v5 offset:11264
    s_waitcnt lgkmcnt(9)
    v_mfma_f32_16x16x32_bf16 v[40:43], a[104:107], a[36:39], v[40:43]
    ds_read_b128 a[104:107], v5 offset:12288
    s_waitcnt lgkmcnt(9)
    v_mfma_f32_16x16x32_bf16 v[44:47], a[108:111], a[36:39], v[44:47]
    ds_read_b128 a[108:111], v7 offset:9216
    s_waitcnt vmcnt(7)
    s_waitcnt lgkmcnt(9)
    v_mfma_f32_16x16x32_bf16 v[28:31], a[72:75], a[40:43], v[28:31]
    ds_read_b128 a[72:75], v5 offset:13824
    s_waitcnt lgkmcnt(9)
    v_mfma_f32_16x16x32_bf16 v[32:35], a[76:79], a[40:43], v[32:35]
    ds_read_b128 a[76:79], v5 offset:14848
    s_waitcnt lgkmcnt(9)
    v_mfma_f32_16x16x32_bf16 v[36:39], a[80:83], a[40:43], v[36:39]
    ds_read_b128 a[80:83], v5 offset:15872
    s_waitcnt lgkmcnt(9)
    v_mfma_f32_16x16x32_bf16 v[40:43], a[84:87], a[40:43], v[40:43]
    ds_read_b128 a[84:87], v5 offset:16896
    s_waitcnt lgkmcnt(9)
    v_mfma_f32_16x16x32_bf16 v[44:47], a[88:91], a[40:43], v[44:47]
    ds_read_b128 a[88:91], v7 offset:13824
    s_waitcnt vmcnt(6)
    s_waitcnt lgkmcnt(9)
    v_mfma_f32_16x16x32_bf16 v[28:31], a[92:95], a[44:47], v[28:31]
    ds_read_b128 a[92:95], v5 offset:18432
    s_waitcnt lgkmcnt(9)
    v_mfma_f32_16x16x32_bf16 v[32:35], a[96:99], a[44:47], v[32:35]
    ds_read_b128 a[96:99], v5 offset:19456
    s_waitcnt lgkmcnt(9)
    v_mfma_f32_16x16x32_bf16 v[36:39], a[100:103], a[44:47], v[36:39]
    ds_read_b128 a[100:103], v5 offset:20480
    s_waitcnt lgkmcnt(9)
    v_mfma_f32_16x16x32_bf16 v[40:43], a[104:107], a[44:47], v[40:43]
    ds_read_b128 a[104:107], v5 offset:21504
    s_waitcnt lgkmcnt(9)
    v_mfma_f32_16x16x32_bf16 v[44:47], a[108:111], a[44:47], v[44:47]
    ds_read_b128 a[108:111], v7 offset:18432
    s_waitcnt vmcnt(5)
    s_waitcnt lgkmcnt(9)
    v_mfma_f32_16x16x32_bf16 v[28:31], a[72:75], a[48:51], v[28:31]
    ds_read_b128 a[72:75], v5 offset:23040
    s_waitcnt lgkmcnt(9)
    v_mfma_f32_16x16x32_bf16 v[32:35], a[76:79], a[48:51], v[32:35]
    ds_read_b128 a[76:79], v5 offset:24064
    s_waitcnt lgkmcnt(9)
    v_mfma_f32_16x16x32_bf16 v[36:39], a[80:83], a[48:51], v[36:39]
    ds_read_b128 a[80:83], v5 offset:25088
    s_waitcnt lgkmcnt(9)
    v_mfma_f32_16x16x32_bf16 v[40:43], a[84:87], a[48:51], v[40:43]
    ds_read_b128 a[84:87], v5 offset:26112
    s_waitcnt lgkmcnt(9)
    v_mfma_f32_16x16x32_bf16 v[44:47], a[88:91], a[48:51], v[44:47]
    ds_read_b128 a[88:91], v7 offset:23040
    s_waitcnt vmcnt(4)
    s_waitcnt lgkmcnt(9)
    v_mfma_f32_16x16x32_bf16 v[28:31], a[92:95], a[52:55], v[28:31]
    ds_read_b128 a[92:95], v5 offset:27648
    s_waitcnt lgkmcnt(9)
    v_mfma_f32_16x16x32_bf16 v[32:35], a[96:99], a[52:55], v[32:35]
    ds_read_b128 a[96:99], v5 offset:28672
    s_waitcnt lgkmcnt(9)
    v_mfma_f32_16x16x32_bf16 v[36:39], a[100:103], a[52:55], v[36:39]
    ds_read_b128 a[100:103], v5 offset:29696
    s_waitcnt lgkmcnt(9)
    v_mfma_f32_16x16x32_bf16 v[40:43], a[104:107], a[52:55], v[40:43]
    ds_read_b128 a[104:107], v5 offset:30720
    s_waitcnt lgkmcnt(9)
    v_mfma_f32_16x16x32_bf16 v[44:47], a[108:111], a[52:55], v[44:47]
    ds_read_b128 a[108:111], v7 offset:27648
    s_waitcnt vmcnt(3)
    s_waitcnt lgkmcnt(9)
    v_mfma_f32_16x16x32_bf16 v[28:31], a[72:75], a[56:59], v[28:31]
    ds_read_b128 a[72:75], v5 offset:32256
    s_waitcnt lgkmcnt(9)
    v_mfma_f32_16x16x32_bf16 v[32:35], a[76:79], a[56:59], v[32:35]
    ds_read_b128 a[76:79], v5 offset:33280
    s_waitcnt lgkmcnt(9)
    v_mfma_f32_16x16x32_bf16 v[36:39], a[80:83], a[56:59], v[36:39]
    ds_read_b128 a[80:83], v5 offset:34304
    s_waitcnt lgkmcnt(9)
    v_mfma_f32_16x16x32_bf16 v[40:43], a[84:87], a[56:59], v[40:43]
    ds_read_b128 a[84:87], v5 offset:35328
    s_waitcnt lgkmcnt(9)
    v_mfma_f32_16x16x32_bf16 v[44:47], a[88:91], a[56:59], v[44:47]
    ds_read_b128 a[88:91], v7 offset:32256
    s_waitcnt vmcnt(2)
    s_waitcnt lgkmcnt(9)
    v_mfma_f32_16x16x32_bf16 v[28:31], a[92:95], a[60:63], v[28:31]
    ds_read_b128 a[92:95], v5 offset:36864
    s_waitcnt lgkmcnt(9)
    v_mfma_f32_16x16x32_bf16 v[32:35], a[96:99], a[60:63], v[32:35]
    ds_read_b128 a[96:99], v5 offset:37888
    s_waitcnt lgkmcnt(9)
    v_mfma_f32_16x16x32_bf16 v[36:39], a[100:103], a[60:63], v[36:39]
    ds_read_b128 a[100:103], v5 offset:38912
    s_waitcnt lgkmcnt(9)
    v_mfma_f32_16x16x32_bf16 v[40:43], a[104:107], a[60:63], v[40:43]
    ds_read_b128 a[104:107], v5 offset:39936
    s_waitcnt lgkmcnt(9)
    v_mfma_f32_16x16x32_bf16 v[44:47], a[108:111], a[60:63], v[44:47]
    ds_read_b128 a[108:111], v7 offset:36864
    s_waitcnt vmcnt(1)
    s_waitcnt lgkmcnt(9)
    v_mfma_f32_16x16x32_bf16 v[28:31], a[72:75], a[64:67], v[28:31]
    s_waitcnt lgkmcnt(8)
    v_mfma_f32_16x16x32_bf16 v[32:35], a[76:79], a[64:67], v[32:35]
    s_waitcnt lgkmcnt(7)
    v_mfma_f32_16x16x32_bf16 v[36:39], a[80:83], a[64:67], v[36:39]
    s_waitcnt lgkmcnt(6)
    v_mfma_f32_16x16x32_bf16 v[40:43], a[84:87], a[64:67], v[40:43]
    s_waitcnt lgkmcnt(5)
    v_mfma_f32_16x16x32_bf16 v[44:47], a[88:91], a[64:67], v[44:47]
    s_waitcnt vmcnt(0)
    s_waitcnt lgkmcnt(4)
    v_mfma_f32_16x16x32_bf16 v[28:31], a[92:95], a[68:71], v[28:31]
    s_waitcnt lgkmcnt(3)
    v_mfma_f32_16x16x32_bf16 v[32:35], a[96:99], a[68:71], v[32:35]
    s_waitcnt lgkmcnt(2)
    v_mfma_f32_16x16x32_bf16 v[36:39], a[100:103], a[68:71], v[36:39]
    s_waitcnt lgkmcnt(1)
    v_mfma_f32_16x16x32_bf16 v[40:43], a[104:107], a[68:71], v[40:43]
    s_waitcnt lgkmcnt(0)
    v_mfma_f32_16x16x32_bf16 v[44:47], a[108:111], a[68:71], v[44:47]
    s_branch L5_pj
L5_py:
    s_mov_b32 s37, 2
    v_lshrrev_b32 v79, 4, v2
    v_lshlrev_b32 v79, 9, v79
    v_and_b32 v78, 15, v2
    v_lshl_add_u32 v79, v78, 1, v79
    s_add_u32 s42, s17, 4096
    s_add_u32 s43, s17, 8192
    buffer_load_short_d16_hi v80, v79, s[4:7], s17 offen offset:0 sc1
    buffer_load_short_d16_hi v81, v79, s[4:7], s17 offen offset:128 sc1
    buffer_load_short_d16_hi v82, v79, s[4:7], s17 offen offset:256 sc1
    buffer_load_short_d16_hi v83, v79, s[4:7], s17 offen offset:384 sc1
    buffer_load_short_d16_hi v84, v79, s[4:7], s17 offen offset:2048 sc1
    buffer_load_short_d16_hi v85, v79, s[4:7], s17 offen offset:2176 sc1
    buffer_load_short_d16_hi v86, v79, s[4:7], s17 offen offset:2304 sc1
    buffer_load_short_d16_hi v87, v79, s[4:7], s17 offen offset:2432 sc1
    buffer_load_short_d16_hi v88, v79, s[4:7], s42 offen offset:0 sc1
    buffer_load_short_d16_hi v89, v79, s[4:7], s42 offen offset:128 sc1
    buffer_load_short_d16_hi v90, v79, s[4:7], s42 offen offset:256 sc1
    buffer_load_short_d16_hi v91, v79, s[4:7], s42 offen offset:384 sc1
    buffer_load_short_d16_hi v92, v79, s[4:7], s42 offen offset:2048 sc1
    buffer_load_short_d16_hi v93, v79, s[4:7], s42 offen offset:2176 sc1
    buffer_load_short_d16_hi v94, v79, s[4:7], s42 offen offset:2304 sc1
    buffer_load_short_d16_hi v95, v79, s[4:7], s42 offen offset:2432 sc1
    s_mov_b64 exec, s[50:51]
    buffer_load_short_d16_hi v96, v79, s[4:7], s43 offen offset:0 sc1
    buffer_load_short_d16_hi v97, v79, s[4:7], s43 offen offset:128 sc1
    buffer_load_short_d16_hi v98, v79, s[4:7], s43 offen offset:256 sc1
    buffer_load_short_d16_hi v99, v79, s[4:7], s43 offen offset:384 sc1
    s_mov_b64 exec, -1
    s_waitcnt vmcnt(37)
    s_waitcnt lgkmcnt(9)
    v_mfma_f32_16x16x32_bf16 v[28:31], a[72:75], a[0:3], 0
    ds_read_b128 a[72:75], v4 offset:9216
    s_waitcnt lgkmcnt(9)
    v_mfma_f32_16x16x32_bf16 v[32:35], a[76:79], a[0:3], 0
    ds_read_b128 a[76:79], v4 offset:10240
    s_waitcnt lgkmcnt(9)
    v_mfma_f32_16x16x32_bf16 v[36:39], a[80:83], a[0:3], 0
    ds_read_b128 a[80:83], v4 offset:11264
    s_waitcnt lgkmcnt(9)
    v_mfma_f32_16x16x32_bf16 v[40:43], a[84:87], a[0:3], 0
    ds_read_b128 a[84:87], v4 offset:12288
    s_waitcnt lgkmcnt(9)
    v_mfma_f32_16x16x32_bf16 v[44:47], a[88:91], a[0:3], 0
    ds_read_b128 a[88:91], v6 offset:9216
    s_waitcnt vmcnt(36)
    s_waitcnt lgkmcnt(9)
    v_mfma_f32_16x16x32_bf16 v[28:31], a[92:95], a[4:7], v[28:31]
    ds_read_b128 a[92:95], v4 offset:13824
    s_waitcnt lgkmcnt(9)
    v_mfma_f32_16x16x32_bf16 v[32:35], a[96:99], a[4:7], v[32:35]
    ds_read_b128 a[96:99], v4 offset:14848
    s_waitcnt lgkmcnt(9)
    v_mfma_f32_16x16x32_bf16 v[36:39], a[100:103], a[4:7], v[36:39]
    ds_read_b128 a[100:103], v4 offset:15872
    s_waitcnt lgkmcnt(9)
    v_mfma_f32_16x16x32_bf16 v[40:43], a[104:107], a[4:7], v[40:43]
    ds_read_b128 a[104:107], v4 offset:16896
    s_waitcnt lgkmcnt(9)
    v_mfma_f32_16x16x32_bf16 v[44:47], a[108:111], a[4:7], v[44:47]
    ds_read_b128 a[108:111], v6 offset:13824
    s_waitcnt vmcnt(35)
    s_waitcnt lgkmcnt(9)
    v_mfma_f32_16x16x32_bf16 v[28:31], a[72:75], a[8:11], v[28:31]
    ds_read_b128 a[72:75], v4 offset:18432
    s_waitcnt lgkmcnt(9)
    v_mfma_f32_16x16x32_bf16 v[32:35], a[76:79], a[8:11], v[32:35]
    ds_read_b128 a[76:79], v4 offset:19456
    s_waitcnt lgkmcnt(9)
    v_mfma_f32_16x16x32_bf16 v[36:39], a[80:83], a[8:11], v[36:39]
    ds_read_b128 a[80:83], v4 offset:20480
    s_waitcnt lgkmcnt(9)
    v_mfma_f32_16x16x32_bf16 v[40:43], a[84:87], a[8:11], v[40:43]
    ds_read_b128 a[84:87], v4 offset:21504
    s_waitcnt lgkmcnt(9)
    v_mfma_f32_16x16x32_bf16 v[44:47], a[88:91], a[8:11], v[44:47]
    ds_read_b128 a[88:91], v6 offset:18432
    s_waitcnt vmcnt(34)
    s_waitcnt lgkmcnt(9)
    v_mfma_f32_16x16x32_bf16 v[28:31], a[92:95], a[12:15], v[28:31]
    ds_read_b128 a[92:95], v4 offset:23040
    s_waitcnt lgkmcnt(9)
    v_mfma_f32_16x16x32_bf16 v[32:35], a[96:99], a[12:15], v[32:35]
    ds_read_b128 a[96:99], v4 offset:24064
    s_waitcnt lgkmcnt(9)
    v_mfma_f32_16x16x32_bf16 v[36:39], a[100:103], a[12:15], v[36:39]
    ds_read_b128 a[100:103], v4 offset:25088
    s_waitcnt lgkmcnt(9)
    v_mfma_f32_16x16x32_bf16 v[40:43], a[104:107], a[12:15], v[40:43]
    ds_read_b128 a[104:107], v4 offset:26112
    s_waitcnt lgkmcnt(9)
    v_mfma_f32_16x16x32_bf16 v[44:47], a[108:111], a[12:15], v[44:47]
    ds_read_b128 a[108:111], v6 offset:23040
    s_waitcnt vmcnt(33)
    s_waitcnt lgkmcnt(9)
    v_mfma_f32_16x16x32_bf16 v[28:31], a[72:75], a[16:19], v[28:31]
    ds_read_b128 a[72:75], v4 offset:27648
    s_waitcnt lgkmcnt(9)
    v_mfma_f32_16x16x32_bf16 v[32:35], a[76:79], a[16:19], v[32:35]
    ds_read_b128 a[76:79], v4 offset:28672
    s_waitcnt lgkmcnt(9)
    v_mfma_f32_16x16x32_bf16 v[36:39], a[80:83], a[16:19], v[36:39]
    ds_read_b128 a[80:83], v4 offset:29696
    s_waitcnt lgkmcnt(9)
    v_mfma_f32_16x16x32_bf16 v[40:43], a[84:87], a[16:19], v[40:43]
    ds_read_b128 a[84:87], v4 offset:30720
    s_waitcnt lgkmcnt(9)
    v_mfma_f32_16x16x32_bf16 v[44:47], a[88:91], a[16:19], v[44:47]
    ds_read_b128 a[88:91], v6 offset:27648
    s_waitcnt vmcnt(32)
    s_waitcnt lgkmcnt(9)
    v_mfma_f32_16x16x32_bf16 v[28:31], a[92:95], a[20:23], v[28:31]
    ds_read_b128 a[92:95], v4 offset:32256
    s_waitcnt lgkmcnt(9)
    v_mfma_f32_16x16x32_bf16 v[32:35], a[96:99], a[20:23], v[32:35]
    ds_read_b128 a[96:99], v4 offset:33280
    s_waitcnt lgkmcnt(9)
    v_mfma_f32_16x16x32_bf16 v[36:39], a[100:103], a[20:23], v[36:39]
    ds_read_b128 a[100:103], v4 offset:34304
    s_waitcnt lgkmcnt(9)
    v_mfma_f32_16x16x32_bf16 v[40:43], a[104:107], a[20:23], v[40:43]
    ds_read_b128 a[104:107], v4 offset:35328
    s_waitcnt lgkmcnt(9)
    v_mfma_f32_16x16x32_bf16 v[44:47], a[108:111], a[20:23], v[44:47]
    ds_read_b128 a[108:111], v6 offset:32256
    s_waitcnt vmcnt(31)
    s_waitcnt lgkmcnt(9)
    v_mfma_f32_16x16x32_bf16 v[28:31], a[72:75], a[24:27], v[28:31]
    ds_read_b128 a[72:75], v4 offset:36864
    s_waitcnt lgkmcnt(9)
    v_mfma_f32_16x16x32_bf16 v[32:35], a[76:79], a[24:27], v[32:35]
    ds_read_b128 a[76:79], v4 offset:37888
    s_waitcnt lgkmcnt(9)
    v_mfma_f32_16x16x32_bf16 v[36:39], a[80:83], a[24:27], v[36:39]
    ds_read_b128 a[80:83], v4 offset:38912
    s_waitcnt lgkmcnt(9)
    v_mfma_f32_16x16x32_bf16 v[40:43], a[84:87], a[24:27], v[40:43]
    ds_read_b128 a[84:87], v4 offset:39936
    s_waitcnt lgkmcnt(9)
    v_mfma_f32_16x16x32_bf16 v[44:47], a[88:91], a[24:27], v[44:47]
    ds_read_b128 a[88:91], v6 offset:36864
    s_waitcnt vmcnt(30)
    s_waitcnt lgkmcnt(9)
    v_mfma_f32_16x16x32_bf16 v[28:31], a[92:95], a[28:31], v[28:31]
    ds_read_b128 a[92:95], v5 offset:0
    s_waitcnt lgkmcnt(9)
    v_mfma_f32_16x16x32_bf16 v[32:35], a[96:99], a[28:31], v[32:35]
    ds_read_b128 a[96:99], v5 offset:1024
    s_waitcnt lgkmcnt(9)
    v_mfma_f32_16x16x32_bf16 v[36:39], a[100:103], a[28:31], v[36:39]
    ds_read_b128 a[100:103], v5 offset:2048
    s_waitcnt lgkmcnt(9)
    v_mfma_f32_16x16x32_bf16 v[40:43], a[104:107], a[28:31], v[40:43]
    ds_read_b128 a[104:107], v5 offset:3072
    s_waitcnt lgkmcnt(9)
    v_mfma_f32_16x16x32_bf16 v[44:47], a[108:111], a[28:31], v[44:47]
    ds_read_b128 a[108:111], v7 offset:0
    s_waitcnt vmcnt(29)
    s_waitcnt lgkmcnt(9)
    v_mfma_f32_16x16x32_bf16 v[28:31], a[72:75], a[32:35], v[28:31]
    ds_read_b128 a[72:75], v5 offset:4608
    s_waitcnt lgkmcnt(9)
    v_mfma_f32_16x16x32_bf16 v[32:35], a[76:79], a[32:35], v[32:35]
    ds_read_b128 a[76:79], v5 offset:5632
    s_waitcnt lgkmcnt(9)
    v_mfma_f32_16x16x32_bf16 v[36:39], a[80:83], a[32:35], v[36:39]
    ds_read_b128 a[80:83], v5 offset:6656
    s_waitcnt lgkmcnt(9)
    v_mfma_f32_16x16x32_bf16 v[40:43], a[84:87], a[32:35], v[40:43]
    ds_read_b128 a[84:87], v5 offset:7680
    s_waitcnt lgkmcnt(9)
    v_mfma_f32_16x16x32_bf16 v[44:47], a[88:91], a[32:35], v[44:47]
    ds_read_b128 a[88:91], v7 offset:4608
    s_waitcnt vmcnt(28)
    s_waitcnt lgkmcnt(9)
    v_mfma_f32_16x16x32_bf16 v[28:31], a[92:95], a[36:39], v[28:31]
    ds_read_b128 a[92:95], v5 offset:9216
    s_waitcnt lgkmcnt(9)
    v_mfma_f32_16x16x32_bf16 v[32:35], a[96:99], a[36:39], v[32:35]
    ds_read_b128 a[96:99], v5 offset:10240
    s_waitcnt lgkmcnt(9)
    v_mfma_f32_16x16x32_bf16 v[36:39], a[100:103], a[36:39], v[36:39]
    ds_read_b128 a[100:103], v5 offset:11264
    s_waitcnt lgkmcnt(9)
    v_mfma_f32_16x16x32_bf16 v[40:43], a[104:107], a[36:39], v[40:43]
    ds_read_b128 a[104:107], v5 offset:12288
    s_waitcnt lgkmcnt(9)
    v_mfma_f32_16x16x32_bf16 v[44:47], a[108:111], a[36:39], v[44:47]
    ds_read_b128 a[108:111], v7 offset:9216
    s_waitcnt vmcnt(27)
    s_waitcnt lgkmcnt(9)
    v_mfma_f32_16x16x32_bf16 v[28:31], a[72:75], a[40:43], v[28:31]
    ds_read_b128 a[72:75], v5 offset:13824
    s_waitcnt lgkmcnt(9)
    v_mfma_f32_16x16x32_bf16 v[32:35], a[76:79], a[40:43], v[32:35]
    ds_read_b128 a[76:79], v5 offset:14848
    s_waitcnt lgkmcnt(9)
    v_mfma_f32_16x16x32_bf16 v[36:39], a[80:83], a[40:43], v[36:39]
    ds_read_b128 a[80:83], v5 offset:15872
    s_waitcnt lgkmcnt(9)
    v_mfma_f32_16x16x32_bf16 v[40:43], a[84:87], a[40:43], v[40:43]
    ds_read_b128 a[84:87], v5 offset:16896
    s_waitcnt lgkmcnt(9)
    v_mfma_f32_16x16x32_bf16 v[44:47], a[88:91], a[40:43], v[44:47]
    ds_read_b128 a[88:91], v7 offset:13824
    s_waitcnt vmcnt(26)
    s_waitcnt lgkmcnt(9)
    v_mfma_f32_16x16x32_bf16 v[28:31], a[92:95], a[44:47], v[28:31]
    ds_read_b128 a[92:95], v5 offset:18432
    s_waitcnt lgkmcnt(9)
    v_mfma_f32_16x16x32_bf16 v[32:35], a[96:99], a[44:47], v[32:35]
    ds_read_b128 a[96:99], v5 offset:19456
    s_waitcnt lgkmcnt(9)
    v_mfma_f32_16x16x32_bf16 v[36:39], a[100:103], a[44:47], v[36:39]
    ds_read_b128 a[100:103], v5 offset:20480
    s_waitcnt lgkmcnt(9)
    v_mfma_f32_16x16x32_bf16 v[40:43], a[104:107], a[44:47], v[40:43]
    ds_read_b128 a[104:107], v5 offset:21504
    s_waitcnt lgkmcnt(9)
    v_mfma_f32_16x16x32_bf16 v[44:47], a[108:111], a[44:47], v[44:47]
    ds_read_b128 a[108:111], v7 offset:18432
    s_waitcnt vmcnt(25)
    s_waitcnt lgkmcnt(9)
    v_mfma_f32_16x16x32_bf16 v[28:31], a[72:75], a[48:51], v[28:31]
    ds_read_b128 a[72:75], v5 offset:23040
    s_waitcnt lgkmcnt(9)
    v_mfma_f32_16x16x32_bf16 v[32:35], a[76:79], a[48:51], v[32:35]
    ds_read_b128 a[76:79], v5 offset:24064
    s_waitcnt lgkmcnt(9)
    v_mfma_f32_16x16x32_bf16 v[36:39], a[80:83], a[48:51], v[36:39]
    ds_read_b128 a[80:83], v5 offset:25088
    s_waitcnt lgkmcnt(9)
    v_mfma_f32_16x16x32_bf16 v[40:43], a[84:87], a[48:51], v[40:43]
    ds_read_b128 a[84:87], v5 offset:26112
    s_waitcnt lgkmcnt(9)
    v_mfma_f32_16x16x32_bf16 v[44:47], a[88:91], a[48:51], v[44:47]
    ds_read_b128 a[88:91], v7 offset:23040
    s_waitcnt vmcnt(24)
    s_waitcnt lgkmcnt(9)
    v_mfma_f32_16x16x32_bf16 v[28:31], a[92:95], a[52:55], v[28:31]
    ds_read_b128 a[92:95], v5 offset:27648
    s_waitcnt lgkmcnt(9)
    v_mfma_f32_16x16x32_bf16 v[32:35], a[96:99], a[52:55], v[32:35]
    ds_read_b128 a[96:99], v5 offset:28672
    s_waitcnt lgkmcnt(9)
    v_mfma_f32_16x16x32_bf16 v[36:39], a[100:103], a[52:55], v[36:39]
    ds_read_b128 a[100:103], v5 offset:29696
    s_waitcnt lgkmcnt(9)
    v_mfma_f32_16x16x32_bf16 v[40:43], a[104:107], a[52:55], v[40:43]
    ds_read_b128 a[104:107], v5 offset:30720
    s_waitcnt lgkmcnt(9)
    v_mfma_f32_16x16x32_bf16 v[44:47], a[108:111], a[52:55], v[44:47]
    ds_read_b128 a[108:111], v7 offset:27648
    s_waitcnt vmcnt(23)
    s_waitcnt lgkmcnt(9)
    v_mfma_f32_16x16x32_bf16 v[28:31], a[72:75], a[56:59], v[28:31]
    ds_read_b128 a[72:75], v5 offset:32256
    s_waitcnt lgkmcnt(9)
    v_mfma_f32_16x16x32_bf16 v[32:35], a[76:79], a[56:59], v[32:35]
    ds_read_b128 a[76:79], v5 offset:33280
    s_waitcnt lgkmcnt(9)
    v_mfma_f32_16x16x32_bf16 v[36:39], a[80:83], a[56:59], v[36:39]
    ds_read_b128 a[80:83], v5 offset:34304
    s_waitcnt lgkmcnt(9)
    v_mfma_f32_16x16x32_bf16 v[40:43], a[84:87], a[56:59], v[40:43]
    ds_read_b128 a[84:87], v5 offset:35328
    s_waitcnt lgkmcnt(9)
    v_mfma_f32_16x16x32_bf16 v[44:47], a[88:91], a[56:59], v[44:47]
    ds_read_b128 a[88:91], v7 offset:32256
    s_waitcnt vmcnt(22)
    s_waitcnt lgkmcnt(9)
    v_mfma_f32_16x16x32_bf16 v[28:31], a[92:95], a[60:63], v[28:31]
    ds_read_b128 a[92:95], v5 offset:36864
    s_waitcnt lgkmcnt(9)
    v_mfma_f32_16x16x32_bf16 v[32:35], a[96:99], a[60:63], v[32:35]
    ds_read_b128 a[96:99], v5 offset:37888
    s_waitcnt lgkmcnt(9)
    v_mfma_f32_16x16x32_bf16 v[36:39], a[100:103], a[60:63], v[36:39]
    ds_read_b128 a[100:103], v5 offset:38912
    s_waitcnt lgkmcnt(9)
    v_mfma_f32_16x16x32_bf16 v[40:43], a[104:107], a[60:63], v[40:43]
    ds_read_b128 a[104:107], v5 offset:39936
    s_waitcnt lgkmcnt(9)
    v_mfma_f32_16x16x32_bf16 v[44:47], a[108:111], a[60:63], v[44:47]
    ds_read_b128 a[108:111], v7 offset:36864
    s_waitcnt vmcnt(21)
    s_waitcnt lgkmcnt(9)
    v_mfma_f32_16x16x32_bf16 v[28:31], a[72:75], a[64:67], v[28:31]
    s_waitcnt lgkmcnt(8)
    v_mfma_f32_16x16x32_bf16 v[32:35], a[76:79], a[64:67], v[32:35]
    s_waitcnt lgkmcnt(7)
    v_mfma_f32_16x16x32_bf16 v[36:39], a[80:83], a[64:67], v[36:39]
    s_waitcnt lgkmcnt(6)
    v_mfma_f32_16x16x32_bf16 v[40:43], a[84:87], a[64:67], v[40:43]
    s_waitcnt lgkmcnt(5)
    v_mfma_f32_16x16x32_bf16 v[44:47], a[88:91], a[64:67], v[44:47]
    s_waitcnt vmcnt(20)
    s_waitcnt lgkmcnt(4)
    v_mfma_f32_16x16x32_bf16 v[28:31], a[92:95], a[68:71], v[28:31]
    s_waitcnt lgkmcnt(3)
    v_mfma_f32_16x16x32_bf16 v[32:35], a[96:99], a[68:71], v[32:35]
    s_waitcnt lgkmcnt(2)
    v_mfma_f32_16x16x32_bf16 v[36:39], a[100:103], a[68:71], v[36:39]
    s_waitcnt lgkmcnt(1)
    v_mfma_f32_16x16x32_bf16 v[40:43], a[104:107], a[68:71], v[40:43]
    s_waitcnt lgkmcnt(0)
    v_mfma_f32_16x16x32_bf16 v[44:47], a[108:111], a[68:71], v[44:47]
L5_pj:
    s_nop 7
    v_cndmask_b32 v44, 0, v44, s[50:51]
    v_cndmask_b32 v45, 0, v45, s[50:51]
    v_cndmask_b32 v46, 0, v46, s[50:51]
    v_cndmask_b32 v47, 0, v47, s[50:51]
    v_cvt_pk_bf16_f32 v48, v28, v29
    v_cvt_pk_bf16_f32 v49, v30, v31
    v_cvt_pk_bf16_f32 v50, v32, v33
    v_cvt_pk_bf16_f32 v51, v34, v35
    v_cvt_pk_bf16_f32 v52, v36, v37
    v_cvt_pk_bf16_f32 v53, v38, v39
    v_cvt_pk_bf16_f32 v54, v40, v41
    v_cvt_pk_bf16_f32 v55, v42, v43
    v_cvt_pk_bf16_f32 v56, v44, v45
    v_cvt_pk_bf16_f32 v57, v46, v47
    v_lshlrev_b32 v28, 16, v48
    v_and_b32 v29, 0xffff0000, v48
    v_lshlrev_b32 v30, 16, v49
    v_and_b32 v31, 0xffff0000, v49
    v_lshlrev_b32 v32, 16, v50
    v_and_b32 v33, 0xffff0000, v50
    v_lshlrev_b32 v34, 16, v51
    v_and_b32 v35, 0xffff0000, v51
    v_lshlrev_b32 v36, 16, v52
    v_and_b32 v37, 0xffff0000, v52
    v_lshlrev_b32 v38, 16, v53
    v_and_b32 v39, 0xffff0000, v53
    v_lshlrev_b32 v40, 16, v54
    v_and_b32 v41, 0xffff0000, v54
    v_lshlrev_b32 v42, 16, v55
    v_and_b32 v43, 0xffff0000, v55
    v_lshlrev_b32 v44, 16, v56
    v_and_b32 v45, 0xffff0000, v56
    v_lshlrev_b32 v46, 16, v57
    v_and_b32 v47, 0xffff0000, v57
    v_pk_add_f32 v[8:9], v[8:9], v[28:29]
    v_pk_add_f32 v[10:11], v[10:11], v[30:31]
    v_pk_add_f32 v[12:13], v[12:13], v[32:33]
    v_pk_add_f32 v[14:15], v[14:15], v[34:35]
    v_pk_add_f32 v[16:17], v[16:17], v[36:37]
    v_pk_add_f32 v[18:19], v[18:19], v[38:39]
    v_pk_add_f32 v[20:21], v[20:21], v[40:41]
    v_pk_add_f32 v[22:23], v[22:23], v[42:43]
    v_pk_add_f32 v[24:25], v[24:25], v[44:45]
    v_pk_add_f32 v[26:27], v[26:27], v[46:47]
    v_cvt_pk_bf16_f32 v48, v8, v9
    v_cvt_pk_bf16_f32 v49, v10, v11
    v_cvt_pk_bf16_f32 v50, v12, v13
    v_cvt_pk_bf16_f32 v51, v14, v15
    v_cvt_pk_bf16_f32 v52, v16, v17
    v_cvt_pk_bf16_f32 v53, v18, v19
    v_cvt_pk_bf16_f32 v54, v20, v21
    v_cvt_pk_bf16_f32 v55, v22, v23
    v_cvt_pk_bf16_f32 v56, v24, v25
    v_cvt_pk_bf16_f32 v57, v26, v27
    v_dot2_f32_bf16 v72, v48, s48, 0
    v_dot2_f32_bf16 v73, v48, v48, 0
    v_dot2_f32_bf16 v74, v49, s48, 0
    v_dot2_f32_bf16 v75, v49, v49, 0
    v_dot2_f32_bf16 v72, v50, s48, v72
    v_dot2_f32_bf16 v73, v50, v50, v73
    v_dot2_f32_bf16 v74, v51, s48, v74
    v_dot2_f32_bf16 v75, v51, v51, v75
    v_dot2_f32_bf16 v72, v52, s48, v72
    v_dot2_f32_bf16 v73, v52, v52, v73
    v_dot2_f32_bf16 v74, v53, s48, v74
    v_dot2_f32_bf16 v75, v53, v53, v75
    v_dot2_f32_bf16 v72, v54, s48, v72
    v_dot2_f32_bf16 v73, v54, v54, v73
    v_dot2_f32_bf16 v74, v55, s48, v74
    v_dot2_f32_bf16 v75, v55, v55, v75
    v_dot2_f32_bf16 v72, v56, s48, v72
    v_dot2_f32_bf16 v73, v56, v56, v73
    v_dot2_f32_bf16 v74, v57, s48, v74
    v_dot2_f32_bf16 v75, v57, v57, v75
    s_nop 2
    v_pk_add_f32 v[72:73], v[72:73], v[74:75]
    v_mov_b32 v74, v72
    v_mov_b32 v75, v73
    s_nop 0
    v_permlane16_swap_b32 v72, v74
    v_permlane16_swap_b32 v73, v75
    v_add_f32 v72, v72, v74
    v_add_f32 v73, v73, v75
    v_mov_b32 v74, v72
    v_mov_b32 v75, v73
    s_nop 0
    v_permlane32_swap_b32 v72, v74
    v_permlane32_swap_b32 v73, v75
    v_add_f32 v72, v72, v74
    v_add_f32 v73, v73, v75
    v_mov_b32 v74, s94
    v_mov_b32 v75, 0
    s_lshl_b32 s40, s24, 8
    s_add_u32 s40, s40, s16
    s_mov_b64 exec, 0xffff
    buffer_store_dwordx4 v[72:75], v3, s[4:7], s40 offen
    s_mov_b64 exec, -1
    v_lshlrev_b32 v8, 16, v48
    v_and_b32 v9, 0xffff0000, v48
    v_lshlrev_b32 v10, 16, v49
    v_and_b32 v11, 0xffff0000, v49
    v_lshlrev_b32 v12, 16, v50
    v_and_b32 v13, 0xffff0000, v50
    v_lshlrev_b32 v14, 16, v51
    v_and_b32 v15, 0xffff0000, v51
    v_lshlrev_b32 v16, 16, v52
    v_and_b32 v17, 0xffff0000, v52
    v_lshlrev_b32 v18, 16, v53
    v_and_b32 v19, 0xffff0000, v53
    v_lshlrev_b32 v20, 16, v54
    v_and_b32 v21, 0xffff0000, v54
    v_lshlrev_b32 v22, 16, v55
    v_and_b32 v23, 0xffff0000, v55
    v_lshlrev_b32 v24, 16, v56
    v_and_b32 v25, 0xffff0000, v56
    v_lshlrev_b32 v26, 16, v57
    v_and_b32 v27, 0xffff0000, v57
    s_cmp_lg_u32 s37, 0
    s_cbranch_scc1 L5_py2
    s_mov_b32 s37, 2
    v_min_u32 v4, 23, v2
    v_lshlrev_b32 v4, 7, v4
    s_lshl_b32 s42, s24, 12
    s_add_u32 s42, s42, 19992576
L_vp39:
    buffer_load_dword v5, v4, s[4:7], s42 offen offset:0 sc1
    s_waitcnt vmcnt(0)
    v_cmp_ne_u32 vcc, s94, v5
    s_cbranch_vccz L_vpx40
    s_cmp_eq_u32 s28, 0
    s_cbranch_scc1 L_vpx40
    s_sub_u32 s28, s28, 1
    s_branch L_vp39
L_vpx40:
    v_lshrrev_b32 v79, 4, v2
    v_lshlrev_b32 v79, 9, v79
    v_and_b32 v78, 15, v2
    v_lshl_add_u32 v79, v78, 1, v79
    s_add_u32 s42, s17, 4096
    s_add_u32 s43, s17, 8192
    buffer_load_short_d16_hi v80, v79, s[4:7], s17 offen offset:0 sc1
    buffer_load_short_d16_hi v81, v79, s[4:7], s17 offen offset:128 sc1
    buffer_load_short_d16_hi v82, v79, s[4:7], s17 offen offset:256 sc1
    buffer_load_short_d16_hi v83, v79, s[4:7], s17 offen offset:384 sc1
    buffer_load_short_d16_hi v84, v79, s[4:7], s17 offen offset:2048 sc1
    buffer_load_short_d16_hi v85, v79, s[4:7], s17 offen offset:2176 sc1
    buffer_load_short_d16_hi v86, v79, s[4:7], s17 offen offset:2304 sc1
    buffer_load_short_d16_hi v87, v79, s[4:7], s17 offen offset:2432 sc1
    buffer_load_short_d16_hi v88, v79, s[4:7], s42 offen offset:0 sc1
    buffer_load_short_d16_hi v89, v79, s[4:7], s42 offen offset:128 sc1
    buffer_load_short_d16_hi v90, v79, s[4:7], s42 offen offset:256 sc1
    buffer_load_short_d16_hi v91, v79, s[4:7], s42 offen offset:384 sc1
    buffer_load_short_d16_hi v92, v79, s[4:7], s42 offen offset:2048 sc1
    buffer_load_short_d16_hi v93, v79, s[4:7], s42 offen offset:2176 sc1
    buffer_load_short_d16_hi v94, v79, s[4:7], s42 offen offset:2304 sc1
    buffer_load_short_d16_hi v95, v79, s[4:7], s42 offen offset:2432 sc1
    s_mov_b64 exec, s[50:51]
    buffer_load_short_d16_hi v96, v79, s[4:7], s43 offen offset:0 sc1
    buffer_load_short_d16_hi v97, v79, s[4:7], s43 offen offset:128 sc1
    buffer_load_short_d16_hi v98, v79, s[4:7], s43 offen offset:256 sc1
    buffer_load_short_d16_hi v99, v79, s[4:7], s43 offen offset:384 sc1
    s_mov_b64 exec, -1
L5_py2:
L_sp41:
    buffer_load_dwordx4 v[72:75], v3, s[4:7], s16 offen sc1
    buffer_load_dwordx4 v[76:79], v3, s[4:7], s16 offen offset:1024 sc1
    s_waitcnt vmcnt(0)
    v_cmp_ne_u32 vcc, s94, v74
    v_cmp_ne_u32 s[42:43], s94, v78
    s_nop 0
    s_or_b64 vcc, vcc, s[42:43]
    s_cbranch_vccz L_spx42
    s_cmp_eq_u32 s28, 0
    s_cbranch_scc1 L_spx42
    s_sub_u32 s28, s28, 1
    s_branch L_sp41
L_spx42:
    v_pk_add_f32 v[72:73], v[72:73], v[76:77]
    v_mov_b32 v74, v72
    v_mov_b32 v75, v73
    s_nop 0
    v_permlane16_swap_b32 v72, v74
    v_permlane16_swap_b32 v73, v75
    v_add_f32 v72, v72, v74
    v_add_f32 v73, v73, v75
    v_mov_b32 v74, v72
    v_mov_b32 v75, v73
    s_nop 0
    v_permlane32_swap_b32 v72, v74
    v_permlane32_swap_b32 v73, v75
    v_add_f32 v72, v72, v74
    v_add_f32 v73, v73, v75
    v_mul_f32 v72, 0x3ae38e39, v72
    v_mul_f32 v73, 0x3ae38e39, v73
    v_fma_f32 v73, -v72, v72, v73
    v_max_f32 v73, 0, v73
    v_cvt_pk_bf16_f32 v74, v72, v73
    v_lshlrev_b32 v72, 16, v74
    v_and_b32 v73, 0xffff0000, v74
    v_add_f32 v73, 0x3727c5ac, v73
    v_cvt_pk_bf16_f32 v74, v73, v73
    v_lshlrev_b32 v73, 16, v74
    v_sqrt_f32 v73, v73
    s_nop 0
    v_cvt_pk_bf16_f32 v74, v73, v73
    v_lshlrev_b32 v73, 16, v74
    v_rcp_f32 v73, v73
    v_xor_b32 v72, 0x80000000, v72
    v_pk_add_f32 v[48:49], v[8:9], v[72:73] op_sel:[0,0] op_sel_hi:[1,0]
    v_pk_add_f32 v[50:51], v[10:11], v[72:73] op_sel:[0,0] op_sel_hi:[1,0]
    v_pk_add_f32 v[52:53], v[12:13], v[72:73] op_sel:[0,0] op_sel_hi:[1,0]
    v_pk_add_f32 v[54:55], v[14:15], v[72:73] op_sel:[0,0] op_sel_hi:[1,0]
    v_pk_add_f32 v[56:57], v[16:17], v[72:73] op_sel:[0,0] op_sel_hi:[1,0]
    v_pk_add_f32 v[58:59], v[18:19], v[72:73] op_sel:[0,0] op_sel_hi:[1,0]
    v_pk_add_f32 v[60:61], v[20:21], v[72:73] op_sel:[0,0] op_sel_hi:[1,0]
    v_pk_add_f32 v[62:63], v[22:23], v[72:73] op_sel:[0,0] op_sel_hi:[1,0]
    v_pk_add_f32 v[64:65], v[24:25], v[72:73] op_sel:[0,0] op_sel_hi:[1,0]
    v_pk_add_f32 v[66:67], v[26:27], v[72:73] op_sel:[0,0] op_sel_hi:[1,0]
    v_cvt_pk_bf16_f32 v28, v48, v49
    v_cvt_pk_bf16_f32 v29, v50, v51
    v_cvt_pk_bf16_f32 v30, v52, v53
    v_cvt_pk_bf16_f32 v31, v54, v55
    v_cvt_pk_bf16_f32 v32, v56, v57
    v_cvt_pk_bf16_f32 v33, v58, v59
    v_cvt_pk_bf16_f32 v34, v60, v61
    v_cvt_pk_bf16_f32 v35, v62, v63
    v_cvt_pk_bf16_f32 v36, v64, v65
    v_cvt_pk_bf16_f32 v37, v66, v67
    v_lshlrev_b32 v48, 16, v28
    v_and_b32 v49, 0xffff0000, v28
    v_lshlrev_b32 v50, 16, v29
    v_and_b32 v51, 0xffff0000, v29
    v_lshlrev_b32 v52, 16, v30
    v_and_b32 v53, 0xffff0000, v30
    v_lshlrev_b32 v54, 16, v31
    v_and_b32 v55, 0xffff0000, v31
    v_lshlrev_b32 v56, 16, v32
    v_and_b32 v57, 0xffff0000, v32
    v_lshlrev_b32 v58, 16, v33
    v_and_b32 v59, 0xffff0000, v33
    v_lshlrev_b32 v60, 16, v34
    v_and_b32 v61, 0xffff0000, v34
    v_lshlrev_b32 v62, 16, v35
    v_and_b32 v63, 0xffff0000, v35
    v_lshlrev_b32 v64, 16, v36
    v_and_b32 v65, 0xffff0000, v36
    v_lshlrev_b32 v66, 16, v37
    v_and_b32 v67, 0xffff0000, v37
    v_pk_mul_f32 v[48:49], v[48:49], v[72:73] op_sel:[0,1] op_sel_hi:[1,1]
    v_pk_mul_f32 v[50:51], v[50:51], v[72:73] op_sel:[0,1] op_sel_hi:[1,1]
    v_pk_mul_f32 v[52:53], v[52:53], v[72:73] op_sel:[0,1] op_sel_hi:[1,1]
    v_pk_mul_f32 v[54:55], v[54:55], v[72:73] op_sel:[0,1] op_sel_hi:[1,1]
    v_pk_mul_f32 v[56:57], v[56:57], v[72:73] op_sel:[0,1] op_sel_hi:[1,1]
    v_pk_mul_f32 v[58:59], v[58:59], v[72:73] op_sel:[0,1] op_sel_hi:[1,1]
    v_pk_mul_f32 v[60:61], v[60:61], v[72:73] op_sel:[0,1] op_sel_hi:[1,1]
    v_pk_mul_f32 v[62:63], v[62:63], v[72:73] op_sel:[0,1] op_sel_hi:[1,1]
    v_pk_mul_f32 v[64:65], v[64:65], v[72:73] op_sel:[0,1] op_sel_hi:[1,1]
    v_pk_mul_f32 v[66:67], v[66:67], v[72:73] op_sel:[0,1] op_sel_hi:[1,1]
    v_cvt_pk_bf16_f32 v28, v48, v49
    v_cvt_pk_bf16_f32 v29, v50, v51
    v_cvt_pk_bf16_f32 v30, v52, v53
    v_cvt_pk_bf16_f32 v31, v54, v55
    v_cvt_pk_bf16_f32 v32, v56, v57
    v_cvt_pk_bf16_f32 v33, v58, v59
    v_cvt_pk_bf16_f32 v34, v60, v61
    v_cvt_pk_bf16_f32 v35, v62, v63
    v_cvt_pk_bf16_f32 v36, v64, v65
    v_cvt_pk_bf16_f32 v37, v66, v67
    v_lshlrev_b32 v48, 16, v28
    v_and_b32 v49, 0xffff0000, v28
    v_lshlrev_b32 v50, 16, v29
    v_and_b32 v51, 0xffff0000, v29
    v_lshlrev_b32 v52, 16, v30
    v_and_b32 v53, 0xffff0000, v30
    v_lshlrev_b32 v54, 16, v31
    v_and_b32 v55, 0xffff0000, v31
    v_lshlrev_b32 v56, 16, v32
    v_and_b32 v57, 0xffff0000, v32
    v_lshlrev_b32 v58, 16, v33
    v_and_b32 v59, 0xffff0000, v33
    v_lshlrev_b32 v60, 16, v34
    v_and_b32 v61, 0xffff0000, v34
    v_lshlrev_b32 v62, 16, v35
    v_and_b32 v63, 0xffff0000, v35
    v_lshlrev_b32 v64, 16, v36
    v_and_b32 v65, 0xffff0000, v36
    v_lshlrev_b32 v66, 16, v37
    v_and_b32 v67, 0xffff0000, v37
    v_pk_mul_f32 v[48:49], v[48:49], v[80:81]
    v_pk_mul_f32 v[50:51], v[50:51], v[82:83]
    v_pk_mul_f32 v[52:53], v[52:53], v[84:85]
    v_pk_mul_f32 v[54:55], v[54:55], v[86:87]
    v_pk_mul_f32 v[56:57], v[56:57], v[88:89]
    v_pk_mul_f32 v[58:59], v[58:59], v[90:91]
    v_pk_mul_f32 v[60:61], v[60:61], v[92:93]
    v_pk_mul_f32 v[62:63], v[62:63], v[94:95]
    v_pk_mul_f32 v[64:65], v[64:65], v[96:97]
    v_pk_mul_f32 v[66:67], v[66:67], v[98:99]
    v_cvt_pk_bf16_f32 v28, v48, v49
    v_cvt_pk_bf16_f32 v29, v50, v51
    v_cvt_pk_bf16_f32 v30, v52, v53
    v_cvt_pk_bf16_f32 v31, v54, v55
    v_cvt_pk_bf16_f32 v32, v56, v57
    v_cvt_pk_bf16_f32 v33, v58, v59
    v_cvt_pk_bf16_f32 v34, v60, v61
    v_cvt_pk_bf16_f32 v35, v62, v63
    v_cvt_pk_bf16_f32 v36, v64, v65
    v_cvt_pk_bf16_f32 v37, v66, v67
    v_lshlrev_b32 v48, 16, v28
    v_and_b32 v49, 0xffff0000, v28
    v_lshlrev_b32 v50, 16, v29
    v_and_b32 v51, 0xffff0000, v29
    v_lshlrev_b32 v52, 16, v30
    v_and_b32 v53, 0xffff0000, v30
    v_lshlrev_b32 v54, 16, v31
    v_and_b32 v55, 0xffff0000, v31
    v_lshlrev_b32 v56, 16, v32
    v_and_b32 v57, 0xffff0000, v32
    v_lshlrev_b32 v58, 16, v33
    v_and_b32 v59, 0xffff0000, v33
    v_lshlrev_b32 v60, 16, v34
    v_and_b32 v61, 0xffff0000, v34
    v_lshlrev_b32 v62, 16, v35
    v_and_b32 v63, 0xffff0000, v35
    v_lshlrev_b32 v64, 16, v36
    v_and_b32 v65, 0xffff0000, v36
    v_lshlrev_b32 v66, 16, v37
    v_and_b32 v67, 0xffff0000, v37
    v_pk_add_f32 v[8:9], v[8:9], v[48:49]
    v_pk_add_f32 v[10:11], v[10:11], v[50:51]
    v_pk_add_f32 v[12:13], v[12:13], v[52:53]
    v_pk_add_f32 v[14:15], v[14:15], v[54:55]
    v_pk_add_f32 v[16:17], v[16:17], v[56:57]
    v_pk_add_f32 v[18:19], v[18:19], v[58:59]
    v_pk_add_f32 v[20:21], v[20:21], v[60:61]
    v_pk_add_f32 v[22:23], v[22:23], v[62:63]
    v_pk_add_f32 v[24:25], v[24:25], v[64:65]
    v_pk_add_f32 v[26:27], v[26:27], v[66:67]
    v_cvt_pk_bf16_f32 v100, v8, v9
    v_cvt_pk_bf16_f32 v101, v10, v11
    v_cvt_pk_bf16_f32 v102, v12, v13
    v_cvt_pk_bf16_f32 v103, v14, v15
    v_cvt_pk_bf16_f32 v104, v16, v17
    v_cvt_pk_bf16_f32 v105, v18, v19
    v_cvt_pk_bf16_f32 v106, v20, v21
    v_cvt_pk_bf16_f32 v107, v22, v23
    v_cvt_pk_bf16_f32 v108, v24, v25
    v_cvt_pk_bf16_f32 v109, v26, v27
    s_cmp_lg_u32 s32, 0
    s_cbranch_scc1 L5_pout
    s_add_u32 s40, s36, 8388608
    buffer_store_dwordx2 v[100:101], v110, s[4:7], s40 offen offset:0
    buffer_store_dwordx2 v[102:103], v110, s[4:7], s40 offen offset:32
    buffer_store_dwordx2 v[104:105], v110, s[4:7], s40 offen offset:64
    buffer_store_dwordx2 v[106:107], v110, s[4:7], s40 offen offset:96
    s_mov_b64 exec, s[50:51]
    buffer_store_dwordx2 v[108:109], v110, s[4:7], s40 offen offset:128
    s_mov_b64 exec, -1
    v_dot2_f32_bf16 v72, v100, s48, 0
    v_dot2_f32_bf16 v73, v100, v100, 0
    v_dot2_f32_bf16 v74, v101, s48, 0
    v_dot2_f32_bf16 v75, v101, v101, 0
    v_dot2_f32_bf16 v72, v102, s48, v72
    v_dot2_f32_bf16 v73, v102, v102, v73
    v_dot2_f32_bf16 v74, v103, s48, v74
    v_dot2_f32_bf16 v75, v103, v103, v75
    v_dot2_f32_bf16 v72, v104, s48, v72
    v_dot2_f32_bf16 v73, v104, v104, v73
    v_dot2_f32_bf16 v74, v105, s48, v74
    v_dot2_f32_bf16 v75, v105, v105, v75
    v_dot2_f32_bf16 v72, v106, s48, v72
    v_dot2_f32_bf16 v73, v106, v106, v73
    v_dot2_f32_bf16 v74, v107, s48, v74
    v_dot2_f32_bf16 v75, v107, v107, v75
    v_dot2_f32_bf16 v72, v108, s48, v72
    v_dot2_f32_bf16 v73, v108, v108, v73
    v_dot2_f32_bf16 v74, v109, s48, v74
    v_dot2_f32_bf16 v75, v109, v109, v75
    s_nop 2
    v_pk_add_f32 v[72:73], v[72:73], v[74:75]
    v_mov_b32 v74, v72
    v_mov_b32 v75, v73
    s_nop 0
    v_permlane16_swap_b32 v72, v74
    v_permlane16_swap_b32 v73, v75
    v_add_f32 v72, v72, v74
    v_add_f32 v73, v73, v75
    v_mov_b32 v74, v72
    v_mov_b32 v75, v73
    s_nop 0
    v_permlane32_swap_b32 v72, v74
    v_permlane32_swap_b32 v73, v75
    v_add_f32 v72, v72, v74
    v_add_f32 v73, v73, v75
    v_lshlrev_b32 v4, 6, v2
    s_lshl_b32 s40, s35, 10
    s_lshl_b32 s41, s24, 3
    s_add_u32 s40, s40, s41
    s_add_u32 s40, s40, s26
    s_add_u32 s40, s40, 376832
    s_mov_b64 exec, 0xffff
    buffer_store_dwordx2 v[72:73], v4, s[4:7], s40 offen
    s_mov_b64 exec, -1
    s_lshl_b32 s40, s35, 5
    s_lshl_b32 s41, s24, 2
    s_add_u32 s40, s40, s41
    s_add_u32 s40, s40, s27
    s_waitcnt vmcnt(0)
    v_mov_b32 v4, 0
    v_mov_b32 v5, s94
    s_mov_b64 exec, 1
    buffer_store_dword v5, v4, s[4:7], s40 offen offset:1280
    s_mov_b64 exec, -1
    s_mov_b32 s32, 1
    s_add_u32 s38, s38, 9
    s_add_u32 s33, s33, 0
    s_add_u32 s34, s34, 512
    s_add_u32 s15, s15, 1048576
    s_add_u32 s16, s16, 32768
    s_branch L5_al
L5_pout:
    buffer_store_dwordx2 v[100:101], v110, s[8:11], s36 offen offset:0
    buffer_store_dwordx2 v[102:103], v110, s[8:11], s36 offen offset:32
    buffer_store_dwordx2 v[104:105], v110, s[8:11], s36 offen offset:64
    buffer_store_dwordx2 v[106:107], v110, s[8:11], s36 offen offset:96
    s_mov_b64 exec, s[50:51]
    buffer_store_dwordx2 v[108:109], v110, s[8:11], s36 offen offset:128
    s_mov_b64 exec, -1
    s_branch L5_fin
L5_q:
    s_cmp_eq_u32 s3, 3
    s_cbranch_scc1 L5_q3
    s_mul_i32 s33, s3, 18432
    s_add_u32 s33, s33, 82944
    v_lshrrev_b32 v18, 3, v2
    v_and_b32 v19, 7, v2
    v_xor_b32 v19, v19, v18
    v_mul_u32_u24 v102, 2304, v18
    v_lshl_add_u32 v102, v19, 4, v102
    v_add_u32 v103, 1152, v102
    v_lshrrev_b32 v17, 2, v2
    v_lshlrev_b32 v17, 4, v17
    v_add_u32 v17, 160768, v17
    s_mov_b32 s10, 32768
    s_mov_b32 s11, 0x00020000
    s_lshl_b32 s39, s30, 13
    s_add_u32 s39, s39, s26
    s_add_u32 s39, s39, 367616
    s_movk_i32 s54, 2688
    s_movk_i32 s55, 1792
    s_movk_i32 s56, 896
    s_movk_i32 s57, 0
    s_movk_i32 s58, 3200
    s_movk_i32 s59, 2304
    s_movk_i32 s60, 1408
    s_movk_i32 s61, 512
    s_movk_i32 s62, 3712
L_lw43:
    ds_read_b32 v8, v1 offset:40
    s_waitcnt lgkmcnt(0)
    v_readfirstlane_b32 s40, v8
    s_nop 0
    s_cmp_ge_u32 s40, 3
    s_cbranch_scc1 L_lwx44
    s_cmp_eq_u32 s28, 0
    s_cbranch_scc1 L_lwx44
    s_sub_u32 s28, s28, 1
    s_sleep 1
    s_branch L_lw43
L_lwx44:
    s_and_b32 s40, s3, 7
    s_lshl_b32 s41, s23, 3
    s_add_u32 s41, s41, 7
    s_sub_u32 s40, s41, s40
    s_mul_i32 s40, s40, 18432
    s_add_u32 s42, s86, 8388608
    s_addc_u32 s43, s87, 0
    s_cmp_lt_u32 s3, 8
    s_cselect_b64 s[42:43], s[64:65], s[42:43]
    s_add_u32 s8, s42, s40
    s_addc_u32 s9, s43, 0
    s_sub_u32 s8, s8, 2688
    s_subb_u32 s9, s9, 0
    s_add_u32 m0, s33, 0
    s_nop 0
    buffer_load_dwordx4 v102, s[8:11], s54 offen offset:0 sc1 lds
    buffer_load_dwordx4 v102, s[8:11], s55 offen offset:1024 sc1 lds
    buffer_load_dwordx4 v102, s[8:11], s56 offen offset:2048 sc1 lds
    buffer_load_dwordx4 v102, s[8:11], s57 offen offset:3072 sc1 lds
    s_add_u32 m0, s33, 4096
    s_nop 0
    buffer_load_dwordx4 v102, s[8:11], s58 offen offset:0 sc1 lds
    buffer_load_dwordx4 v102, s[8:11], s59 offen offset:1024 sc1 lds
    buffer_load_dwordx4 v102, s[8:11], s60 offen offset:2048 sc1 lds
    buffer_load_dwordx4 v102, s[8:11], s61 offen offset:3072 sc1 lds
    s_add_u32 m0, s33, 8192
    s_nop 0
    buffer_load_dwordx4 v102, s[8:11], s62 offen offset:0 sc1 lds
    s_add_u32 m0, s33, 9216
    s_nop 0
    buffer_load_dwordx4 v103, s[8:11], s54 offen offset:0 sc1 lds
    buffer_load_dwordx4 v103, s[8:11], s55 offen offset:1024 sc1 lds
    buffer_load_dwordx4 v103, s[8:11], s56 offen offset:2048 sc1 lds
    buffer_load_dwordx4 v103, s[8:11], s57 offen offset:3072 sc1 lds
    s_add_u32 m0, s33, 13312
    s_nop 0
    buffer_load_dwordx4 v103, s[8:11], s58 offen offset:0 sc1 lds
    buffer_load_dwordx4 v103, s[8:11], s59 offen offset:1024 sc1 lds
    buffer_load_dwordx4 v103, s[8:11], s60 offen offset:2048 sc1 lds
    buffer_load_dwordx4 v103, s[8:11], s61 offen offset:3072 sc1 lds
    s_add_u32 m0, s33, 17408
    s_nop 0
    buffer_load_dwordx4 v103, s[8:11], s62 offen offset:0 sc1 lds
    v_and_b32 v18, 7, v2
    v_lshrrev_b32 v19, 4, v2
    v_xor_b32 v4, v18, v19
    v_lshlrev_b32 v4, 4, v4
    v_lshl_add_u32 v4, v18, 7, v4
    v_bfe_u32 v18, v2, 3, 1
    v_mul_u32_u24 v18, 9216, v18
    v_add_u32 v4, v4, v18
    v_xor_b32 v5, 64, v4
    v_add_u32 v6, 82944, v4
    v_add_u32 v7, 82944, v5
    v_mov_b32 v12, 1
    v_add_u32 v10, 12, v1
    v_add_u32 v11, s3, v10
    v_and_b32 v18, 15, v2
    v_lshlrev_b32 v13, 4, v18
    v_add_u32 v13, 160768, v13
    v_mul_u32_u24 v14, 240, v18
    v_mov_b32 v96, 0x3f803f80
    v_mov_b32 v97, 0x3f803f80
    v_mov_b32 v98, 0x3f803f80
    v_mov_b32 v99, 0x3f803f80
    s_mov_b32 s51, 0x01010101
    s_mov_b32 s50, 0
    s_mul_i32 s35, s22, 129024
    v_lshl_add_u32 v14, v19, 3, v14
    s_lshl_b32 s40, s3, 6
    s_lshr_b32 s41, s3, 1
    s_lshl_b32 s42, s41, 4
    s_add_u32 s40, s40, s42
    s_lshl_b32 s42, s41, 3
    s_add_u32 s42, s42, 32
    v_add_u32 v14, s40, v14
    v_add_u32 v15, s42, v14
    s_lshl_b32 s40, s3, 11
    s_lshl_b32 s41, s41, 10
    s_add_u32 s35, s35, s40
    s_add_u32 s35, s35, s41
    s_add_u32 s35, s35, 20971520
    s_cmp_ge_u32 s50, 12
    s_cbranch_scc1 L_gtx46
L_gt45:
    ds_read_b32 v100, v1 offset:20
    s_waitcnt lgkmcnt(0)
    v_readfirstlane_b32 s50, v100
    s_nop 0
    s_cmp_ge_u32 s50, 12
    s_cbranch_scc1 L_gtx46
    s_cmp_eq_u32 s28, 0
    s_cbranch_scc1 L_gtx46
    s_sub_u32 s28, s28, 1
    s_sleep 1
    s_branch L_gt45
L_gtx46:
    buffer_load_dwordx4 a[0:3], v3, s[4:7], s35 offen offset:0 sc1
    buffer_load_dwordx4 a[4:7], v3, s[4:7], s35 offen offset:1024 sc1
    s_add_u32 s35, s35, 7168
    s_cmp_ge_u32 s50, 24
    s_cbranch_scc1 L_gtx48
L_gt47:
    ds_read_b32 v100, v1 offset:20
    s_waitcnt lgkmcnt(0)
    v_readfirstlane_b32 s50, v100
    s_nop 0
    s_cmp_ge_u32 s50, 24
    s_cbranch_scc1 L_gtx48
    s_cmp_eq_u32 s28, 0
    s_cbranch_scc1 L_gtx48
    s_sub_u32 s28, s28, 1
    s_sleep 1
    s_branch L_gt47
L_gtx48:
    buffer_load_dwordx4 a[8:11], v3, s[4:7], s35 offen offset:0 sc1
    buffer_load_dwordx4 a[12:15], v3, s[4:7], s35 offen offset:1024 sc1
    s_add_u32 s35, s35, 7168
    s_cmp_ge_u32 s50, 36
    s_cbranch_scc1 L_gtx50
L_gt49:
    ds_read_b32 v100, v1 offset:20
    s_waitcnt lgkmcnt(0)
    v_readfirstlane_b32 s50, v100
    s_nop 0
    s_cmp_ge_u32 s50, 36
    s_cbranch_scc1 L_gtx50
    s_cmp_eq_u32 s28, 0
    s_cbranch_scc1 L_gtx50
    s_sub_u32 s28, s28, 1
    s_sleep 1
    s_branch L_gt49
L_gtx50:
    buffer_load_dwordx4 a[16:19], v3, s[4:7], s35 offen offset:0 sc1
    buffer_load_dwordx4 a[20:23], v3, s[4:7], s35 offen offset:1024 sc1
    s_add_u32 s35, s35, 7168
    s_cmp_ge_u32 s50, 48
    s_cbranch_scc1 L_gtx52
L_gt51:
    ds_read_b32 v100, v1 offset:20
    s_waitcnt lgkmcnt(0)
    v_readfirstlane_b32 s50, v100
    s_nop 0
    s_cmp_ge_u32 s50, 48
    s_cbranch_scc1 L_gtx52
    s_cmp_eq_u32 s28, 0
    s_cbranch_scc1 L_gtx52
    s_sub_u32 s28, s28, 1
    s_sleep 1
    s_branch L_gt51
L_gtx52:
    buffer_load_dwordx4 a[24:27], v3, s[4:7], s35 offen offset:0 sc1
    buffer_load_dwordx4 a[28:31], v3, s[4:7], s35 offen offset:1024 sc1
    s_add_u32 s35, s35, 7168
    s_cmp_ge_u32 s50, 60
    s_cbranch_scc1 L_gtx54
L_gt53:
    ds_read_b32 v100, v1 offset:20
    s_waitcnt lgkmcnt(0)
    v_readfirstlane_b32 s50, v100
    s_nop 0
    s_cmp_ge_u32 s50, 60
    s_cbranch_scc1 L_gtx54
    s_cmp_eq_u32 s28, 0
    s_cbranch_scc1 L_gtx54
    s_sub_u32 s28, s28, 1
    s_sleep 1
    s_branch L_gt53
L_gtx54:
    buffer_load_dwordx4 a[32:35], v3, s[4:7], s35 offen offset:0 sc1
    buffer_load_dwordx4 a[36:39], v3, s[4:7], s35 offen offset:1024 sc1
    s_add_u32 s35, s35, 7168
    s_cmp_ge_u32 s50, 72
    s_cbranch_scc1 L_gtx56
L_gt55:
    ds_read_b32 v100, v1 offset:20
    s_waitcnt lgkmcnt(0)
    v_readfirstlane_b32 s50, v100
    s_nop 0
    s_cmp_ge_u32 s50, 72
    s_cbranch_scc1 L_gtx56
    s_cmp_eq_u32 s28, 0
    s_cbranch_scc1 L_gtx56
    s_sub_u32 s28, s28, 1
    s_sleep 1
    s_branch L_gt55
L_gtx56:
    buffer_load_dwordx4 a[40:43], v3, s[4:7], s35 offen offset:0 sc1
    buffer_load_dwordx4 a[44:47], v3, s[4:7], s35 offen offset:1024 sc1
    s_add_u32 s35, s35, 7168
    s_cmp_ge_u32 s50, 84
    s_cbranch_scc1 L_gtx58
L_gt57:
    ds_read_b32 v100, v1 offset:20
    s_waitcnt lgkmcnt(0)
    v_readfirstlane_b32 s50, v100
    s_nop 0
    s_cmp_ge_u32 s50, 84
    s_cbranch_scc1 L_gtx58
    s_cmp_eq_u32 s28, 0
    s_cbranch_scc1 L_gtx58
    s_sub_u32 s28, s28, 1
    s_sleep 1
    s_branch L_gt57
L_gtx58:
    buffer_load_dwordx4 a[48:51], v3, s[4:7], s35 offen offset:0 sc1
    buffer_load_dwordx4 a[52:55], v3, s[4:7], s35 offen offset:1024 sc1
    s_add_u32 s35, s35, 7168
    s_cmp_ge_u32 s50, 96
    s_cbranch_scc1 L_gtx60
L_gt59:
    ds_read_b32 v100, v1 offset:20
    s_waitcnt lgkmcnt(0)
    v_readfirstlane_b32 s50, v100
    s_nop 0
    s_cmp_ge_u32 s50, 96
    s_cbranch_scc1 L_gtx60
    s_cmp_eq_u32 s28, 0
    s_cbranch_scc1 L_gtx60
    s_sub_u32 s28, s28, 1
    s_sleep 1
    s_branch L_gt59
L_gtx60:
    buffer_load_dwordx4 a[56:59], v3, s[4:7], s35 offen offset:0 sc1
    buffer_load_dwordx4 a[60:63], v3, s[4:7], s35 offen offset:1024 sc1
    s_add_u32 s35, s35, 7168
    s_cmp_ge_u32 s50, 108
    s_cbranch_scc1 L_gtx62
L_gt61:
    ds_read_b32 v100, v1 offset:20
    s_waitcnt lgkmcnt(0)
    v_readfirstlane_b32 s50, v100
    s_nop 0
    s_cmp_ge_u32 s50, 108
    s_cbranch_scc1 L_gtx62
    s_cmp_eq_u32 s28, 0
    s_cbranch_scc1 L_gtx62
    s_sub_u32 s28, s28, 1
    s_sleep 1
    s_branch L_gt61
L_gtx62:
    buffer_load_dwordx4 a[64:67], v3, s[4:7], s35 offen offset:0 sc1
    buffer_load_dwordx4 a[68:71], v3, s[4:7], s35 offen offset:1024 sc1
    s_add_u32 s35, s35, 7168
    s_cmp_ge_u32 s50, 120
    s_cbranch_scc1 L_gtx64
L_gt63:
    ds_read_b32 v100, v1 offset:20
    s_waitcnt lgkmcnt(0)
    v_readfirstlane_b32 s50, v100
    s_nop 0
    s_cmp_ge_u32 s50, 120
    s_cbranch_scc1 L_gtx64
    s_cmp_eq_u32 s28, 0
    s_cbranch_scc1 L_gtx64
    s_sub_u32 s28, s28, 1
    s_sleep 1
    s_branch L_gt63
L_gtx64:
    buffer_load_dwordx4 a[72:75], v3, s[4:7], s35 offen offset:0 sc1
    buffer_load_dwordx4 a[76:79], v3, s[4:7], s35 offen offset:1024 sc1
    s_add_u32 s35, s35, 7168
    s_cmp_ge_u32 s50, 132
    s_cbranch_scc1 L_gtx66
L_gt65:
    ds_read_b32 v100, v1 offset:20
    s_waitcnt lgkmcnt(0)
    v_readfirstlane_b32 s50, v100
    s_nop 0
    s_cmp_ge_u32 s50, 132
    s_cbranch_scc1 L_gtx66
    s_cmp_eq_u32 s28, 0
    s_cbranch_scc1 L_gtx66
    s_sub_u32 s28, s28, 1
    s_sleep 1
    s_branch L_gt65
L_gtx66:
    buffer_load_dwordx4 a[80:83], v3, s[4:7], s35 offen offset:0 sc1
    buffer_load_dwordx4 a[84:87], v3, s[4:7], s35 offen offset:1024 sc1
    s_add_u32 s35, s35, 7168
    s_cmp_ge_u32 s50, 144
    s_cbranch_scc1 L_gtx68
L_gt67:
    ds_read_b32 v100, v1 offset:20
    s_waitcnt lgkmcnt(0)
    v_readfirstlane_b32 s50, v100
    s_nop 0
    s_cmp_ge_u32 s50, 144
    s_cbranch_scc1 L_gtx68
    s_cmp_eq_u32 s28, 0
    s_cbranch_scc1 L_gtx68
    s_sub_u32 s28, s28, 1
    s_sleep 1
    s_branch L_gt67
L_gtx68:
    buffer_load_dwordx4 a[88:91], v3, s[4:7], s35 offen offset:0 sc1
    buffer_load_dwordx4 a[92:95], v3, s[4:7], s35 offen offset:1024 sc1
    s_add_u32 s35, s35, 7168
    s_cmp_ge_u32 s50, 156
    s_cbranch_scc1 L_gtx70
L_gt69:
    ds_read_b32 v100, v1 offset:20
    s_waitcnt lgkmcnt(0)
    v_readfirstlane_b32 s50, v100
    s_nop 0
    s_cmp_ge_u32 s50, 156
    s_cbranch_scc1 L_gtx70
    s_cmp_eq_u32 s28, 0
    s_cbranch_scc1 L_gtx70
    s_sub_u32 s28, s28, 1
    s_sleep 1
    s_branch L_gt69
L_gtx70:
    buffer_load_dwordx4 a[96:99], v3, s[4:7], s35 offen offset:0 sc1
    buffer_load_dwordx4 a[100:103], v3, s[4:7], s35 offen offset:1024 sc1
    s_add_u32 s35, s35, 7168
    s_cmp_ge_u32 s50, 168
    s_cbranch_scc1 L_gtx72
L_gt71:
    ds_read_b32 v100, v1 offset:20
    s_waitcnt lgkmcnt(0)
    v_readfirstlane_b32 s50, v100
    s_nop 0
    s_cmp_ge_u32 s50, 168
    s_cbranch_scc1 L_gtx72
    s_cmp_eq_u32 s28, 0
    s_cbranch_scc1 L_gtx72
    s_sub_u32 s28, s28, 1
    s_sleep 1
    s_branch L_gt71
L_gtx72:
    buffer_load_dwordx4 a[104:107], v3, s[4:7], s35 offen offset:0 sc1
    buffer_load_dwordx4 a[108:111], v3, s[4:7], s35 offen offset:1024 sc1
    s_add_u32 s35, s35, 7168
    s_cmp_ge_u32 s50, 180
    s_cbranch_scc1 L_gtx74
L_gt73:
    ds_read_b32 v100, v1 offset:20
    s_waitcnt lgkmcnt(0)
    v_readfirstlane_b32 s50, v100
    s_nop 0
    s_cmp_ge_u32 s50, 180
    s_cbranch_scc1 L_gtx74
    s_cmp_eq_u32 s28, 0
    s_cbranch_scc1 L_gtx74
    s_sub_u32 s28, s28, 1
    s_sleep 1
    s_branch L_gt73
L_gtx74:
    buffer_load_dwordx4 a[112:115], v3, s[4:7], s35 offen offset:0 sc1
    buffer_load_dwordx4 a[116:119], v3, s[4:7], s35 offen offset:1024 sc1
    s_add_u32 s35, s35, 7168
    s_cmp_ge_u32 s50, 192
    s_cbranch_scc1 L_gtx76
L_gt75:
    ds_read_b32 v100, v1 offset:20
    s_waitcnt lgkmcnt(0)
    v_readfirstlane_b32 s50, v100
    s_nop 0
    s_cmp_ge_u32 s50, 192
    s_cbranch_scc1 L_gtx76
    s_cmp_eq_u32 s28, 0
    s_cbranch_scc1 L_gtx76
    s_sub_u32 s28, s28, 1
    s_sleep 1
    s_branch L_gt75
L_gtx76:
    buffer_load_dwordx4 a[120:123], v3, s[4:7], s35 offen offset:0 sc1
    buffer_load_dwordx4 a[124:127], v3, s[4:7], s35 offen offset:1024 sc1
    s_add_u32 s35, s35, 7168
    s_cmp_ge_u32 s50, 204
    s_cbranch_scc1 L_gtx78
L_gt77:
    ds_read_b32 v100, v1 offset:20
    s_waitcnt lgkmcnt(0)
    v_readfirstlane_b32 s50, v100
    s_nop 0
    s_cmp_ge_u32 s50, 204
    s_cbranch_scc1 L_gtx78
    s_cmp_eq_u32 s28, 0
    s_cbranch_scc1 L_gtx78
    s_sub_u32 s28, s28, 1
    s_sleep 1
    s_branch L_gt77
L_gtx78:
    buffer_load_dwordx4 a[128:131], v3, s[4:7], s35 offen offset:0 sc1
    buffer_load_dwordx4 a[132:135], v3, s[4:7], s35 offen offset:1024 sc1
    s_add_u32 s35, s35, 7168
    s_cmp_ge_u32 s50, 216
    s_cbranch_scc1 L_gtx80
L_gt79:
    ds_read_b32 v100, v1 offset:20
    s_waitcnt lgkmcnt(0)
    v_readfirstlane_b32 s50, v100
    s_nop 0
    s_cmp_ge_u32 s50, 216
    s_cbranch_scc1 L_gtx80
    s_cmp_eq_u32 s28, 0
    s_cbranch_scc1 L_gtx80
    s_sub_u32 s28, s28, 1
    s_sleep 1
    s_branch L_gt79
L_gtx80:
    buffer_load_dwordx4 a[136:139], v3, s[4:7], s35 offen offset:0 sc1
    buffer_load_dwordx4 a[140:143], v3, s[4:7], s35 offen offset:1024 sc1
    v_mov_b32 v18, 1
    s_mov_b64 exec, 1
    ds_add_u32 v1, v18 offset:44
    s_mov_b64 exec, -1
    s_waitcnt vmcnt(36)
    v_mov_b32 v18, 1
    s_mov_b64 exec, 1
    ds_add_u32 v1, v18 offset:72
    s_mov_b64 exec, -1
L_lw81:
    ds_read_b32 v18, v1 offset:72
    s_waitcnt lgkmcnt(0)
    v_readfirstlane_b32 s40, v18
    s_nop 0
    s_cmp_ge_u32 s40, 3
    s_cbranch_scc1 L_lwx82
    s_cmp_eq_u32 s28, 0
    s_cbranch_scc1 L_lwx82
    s_sub_u32 s28, s28, 1
    s_branch L_lw81
L_lwx82:
    ds_read_b128 v[72:75], v6 offset:0
    ds_read_b128 v[76:79], v6 offset:18432
    ds_read_b128 v[80:83], v6 offset:36864
    ds_read_b128 v[84:87], v7 offset:0
    ds_read_b128 v[88:91], v7 offset:18432
    ds_read_b128 v[92:95], v7 offset:36864
    s_waitcnt vmcnt(34)
    v_mfma_f32_16x16x32_bf16 v[24:27], a[0:3], v[96:99], 0
    v_mfma_f32_16x16x32_bf16 v[28:31], a[4:7], v[96:99], 0
    s_waitcnt lgkmcnt(5)
    v_mfma_f32_16x16x32_bf16 v[48:51], a[0:3], v[72:75], 0
    v_mfma_f32_16x16x32_bf16 v[52:55], a[4:7], v[72:75], 0
    s_waitcnt lgkmcnt(4)
    v_mfma_f32_16x16x32_bf16 v[56:59], a[0:3], v[76:79], 0
    v_mfma_f32_16x16x32_bf16 v[60:63], a[4:7], v[76:79], 0
    s_waitcnt lgkmcnt(3)
    v_mfma_f32_16x16x32_bf16 v[32:35], a[0:3], v[80:83], 0
    v_mfma_f32_16x16x32_bf16 v[36:39], a[4:7], v[80:83], 0
    ds_read_b128 v[72:75], v6 offset:1024
    ds_read_b128 v[76:79], v6 offset:19456
    ds_read_b128 v[80:83], v6 offset:37888
    s_waitcnt vmcnt(32)
    v_mfma_f32_16x16x32_bf16 v[24:27], a[8:11], v[96:99], v[24:27]
    v_mfma_f32_16x16x32_bf16 v[28:31], a[12:15], v[96:99], v[28:31]
    s_waitcnt lgkmcnt(5)
    v_mfma_f32_16x16x32_bf16 v[48:51], a[8:11], v[84:87], v[48:51]
    v_mfma_f32_16x16x32_bf16 v[52:55], a[12:15], v[84:87], v[52:55]
    s_waitcnt lgkmcnt(4)
    v_mfma_f32_16x16x32_bf16 v[56:59], a[8:11], v[88:91], v[56:59]
    v_mfma_f32_16x16x32_bf16 v[60:63], a[12:15], v[88:91], v[60:63]
    s_waitcnt lgkmcnt(3)
    v_mfma_f32_16x16x32_bf16 v[32:35], a[8:11], v[92:95], v[32:35]
    v_mfma_f32_16x16x32_bf16 v[36:39], a[12:15], v[92:95], v[36:39]
    ds_read_b128 v[84:87], v7 offset:1024
    ds_read_b128 v[88:91], v7 offset:19456
    ds_read_b128 v[92:95], v7 offset:37888
    s_waitcnt vmcnt(30)
    v_mfma_f32_16x16x32_bf16 v[24:27], a[16:19], v[96:99], v[24:27]
    v_mfma_f32_16x16x32_bf16 v[28:31], a[20:23], v[96:99], v[28:31]
    s_waitcnt lgkmcnt(5)
    v_mfma_f32_16x16x32_bf16 v[48:51], a[16:19], v[72:75], v[48:51]
    v_mfma_f32_16x16x32_bf16 v[52:55], a[20:23], v[72:75], v[52:55]
    s_waitcnt lgkmcnt(4)
    v_mfma_f32_16x16x32_bf16 v[56:59], a[16:19], v[76:79], v[56:59]
    v_mfma_f32_16x16x32_bf16 v[60:63], a[20:23], v[76:79], v[60:63]
    s_waitcnt lgkmcnt(3)
    v_mfma_f32_16x16x32_bf16 v[32:35], a[16:19], v[80:83], v[32:35]
    v_mfma_f32_16x16x32_bf16 v[36:39], a[20:23], v[80:83], v[36:39]
    ds_read_b128 v[72:75], v6 offset:2048
    ds_read_b128 v[76:79], v6 offset:20480
    ds_read_b128 v[80:83], v6 offset:38912
    s_waitcnt vmcnt(28)
    v_mfma_f32_16x16x32_bf16 v[24:27], a[24:27], v[96:99], v[24:27]
    v_mfma_f32_16x16x32_bf16 v[28:31], a[28:31], v[96:99], v[28:31]
    s_waitcnt lgkmcnt(5)
    v_mfma_f32_16x16x32_bf16 v[48:51], a[24:27], v[84:87], v[48:51]
    v_mfma_f32_16x16x32_bf16 v[52:55], a[28:31], v[84:87], v[52:55]
    s_waitcnt lgkmcnt(4)
    v_mfma_f32_16x16x32_bf16 v[56:59], a[24:27], v[88:91], v[56:59]
    v_mfma_f32_16x16x32_bf16 v[60:63], a[28:31], v[88:91], v[60:63]
    s_waitcnt lgkmcnt(3)
    v_mfma_f32_16x16x32_bf16 v[32:35], a[24:27], v[92:95], v[32:35]
    v_mfma_f32_16x16x32_bf16 v[36:39], a[28:31], v[92:95], v[36:39]
    ds_read_b128 v[84:87], v7 offset:2048
    ds_read_b128 v[88:91], v7 offset:20480
    ds_read_b128 v[92:95], v7 offset:38912
    s_waitcnt vmcnt(26)
    v_mfma_f32_16x16x32_bf16 v[24:27], a[32:35], v[96:99], v[24:27]
    v_mfma_f32_16x16x32_bf16 v[28:31], a[36:39], v[96:99], v[28:31]
    s_waitcnt lgkmcnt(5)
    v_mfma_f32_16x16x32_bf16 v[48:51], a[32:35], v[72:75], v[48:51]
    v_mfma_f32_16x16x32_bf16 v[52:55], a[36:39], v[72:75], v[52:55]
    s_waitcnt lgkmcnt(4)
    v_mfma_f32_16x16x32_bf16 v[56:59], a[32:35], v[76:79], v[56:59]
    v_mfma_f32_16x16x32_bf16 v[60:63], a[36:39], v[76:79], v[60:63]
    s_waitcnt lgkmcnt(3)
    v_mfma_f32_16x16x32_bf16 v[32:35], a[32:35], v[80:83], v[32:35]
    v_mfma_f32_16x16x32_bf16 v[36:39], a[36:39], v[80:83], v[36:39]
    ds_read_b128 v[72:75], v6 offset:3072
    ds_read_b128 v[76:79], v6 offset:21504
    ds_read_b128 v[80:83], v6 offset:39936
    s_waitcnt vmcnt(24)
    v_mfma_f32_16x16x32_bf16 v[24:27], a[40:43], v[96:99], v[24:27]
    v_mfma_f32_16x16x32_bf16 v[28:31], a[44:47], v[96:99], v[28:31]
    s_waitcnt lgkmcnt(5)
    v_mfma_f32_16x16x32_bf16 v[48:51], a[40:43], v[84:87], v[48:51]
    v_mfma_f32_16x16x32_bf16 v[52:55], a[44:47], v[84:87], v[52:55]
    s_waitcnt lgkmcnt(4)
    v_mfma_f32_16x16x32_bf16 v[56:59], a[40:43], v[88:91], v[56:59]
    v_mfma_f32_16x16x32_bf16 v[60:63], a[44:47], v[88:91], v[60:63]
    s_waitcnt lgkmcnt(3)
    v_mfma_f32_16x16x32_bf16 v[32:35], a[40:43], v[92:95], v[32:35]
    v_mfma_f32_16x16x32_bf16 v[36:39], a[44:47], v[92:95], v[36:39]
    ds_read_b128 v[84:87], v7 offset:3072
    ds_read_b128 v[88:91], v7 offset:21504
    ds_read_b128 v[92:95], v7 offset:39936
    s_waitcnt vmcnt(22)
    v_mfma_f32_16x16x32_bf16 v[24:27], a[48:51], v[96:99], v[24:27]
    v_mfma_f32_16x16x32_bf16 v[28:31], a[52:55], v[96:99], v[28:31]
    s_waitcnt lgkmcnt(5)
    v_mfma_f32_16x16x32_bf16 v[48:51], a[48:51], v[72:75], v[48:51]
    v_mfma_f32_16x16x32_bf16 v[52:55], a[52:55], v[72:75], v[52:55]
    s_waitcnt lgkmcnt(4)
    v_mfma_f32_16x16x32_bf16 v[56:59], a[48:51], v[76:79], v[56:59]
    v_mfma_f32_16x16x32_bf16 v[60:63], a[52:55], v[76:79], v[60:63]
    s_waitcnt lgkmcnt(3)
    v_mfma_f32_16x16x32_bf16 v[32:35], a[48:51], v[80:83], v[32:35]
    v_mfma_f32_16x16x32_bf16 v[36:39], a[52:55], v[80:83], v[36:39]
    ds_read_b128 v[72:75], v6 offset:4096
    ds_read_b128 v[76:79], v6 offset:22528
    ds_read_b128 v[80:83], v6 offset:40960
    s_waitcnt vmcnt(20)
    v_mfma_f32_16x16x32_bf16 v[24:27], a[56:59], v[96:99], v[24:27]
    v_mfma_f32_16x16x32_bf16 v[28:31], a[60:63], v[96:99], v[28:31]
    s_waitcnt lgkmcnt(5)
    v_mfma_f32_16x16x32_bf16 v[48:51], a[56:59], v[84:87], v[48:51]
    v_mfma_f32_16x16x32_bf16 v[52:55], a[60:63], v[84:87], v[52:55]
    s_waitcnt lgkmcnt(4)
    v_mfma_f32_16x16x32_bf16 v[56:59], a[56:59], v[88:91], v[56:59]
    v_mfma_f32_16x16x32_bf16 v[60:63], a[60:63], v[88:91], v[60:63]
    s_waitcnt lgkmcnt(3)
    v_mfma_f32_16x16x32_bf16 v[32:35], a[56:59], v[92:95], v[32:35]
    v_mfma_f32_16x16x32_bf16 v[36:39], a[60:63], v[92:95], v[36:39]
    ds_read_b128 v[84:87], v7 offset:4096
    ds_read_b128 v[88:91], v7 offset:22528
    ds_read_b128 v[92:95], v7 offset:40960
    s_waitcnt vmcnt(18)
    v_mfma_f32_16x16x32_bf16 v[24:27], a[64:67], v[96:99], v[24:27]
    v_mfma_f32_16x16x32_bf16 v[28:31], a[68:71], v[96:99], v[28:31]
    s_waitcnt lgkmcnt(5)
    v_mfma_f32_16x16x32_bf16 v[48:51], a[64:67], v[72:75], v[48:51]
    v_mfma_f32_16x16x32_bf16 v[52:55], a[68:71], v[72:75], v[52:55]
    s_waitcnt lgkmcnt(4)
    v_mfma_f32_16x16x32_bf16 v[56:59], a[64:67], v[76:79], v[56:59]
    v_mfma_f32_16x16x32_bf16 v[60:63], a[68:71], v[76:79], v[60:63]
    s_waitcnt lgkmcnt(3)
    v_mfma_f32_16x16x32_bf16 v[32:35], a[64:67], v[80:83], v[32:35]
    v_mfma_f32_16x16x32_bf16 v[36:39], a[68:71], v[80:83], v[36:39]
    ds_read_b128 v[72:75], v6 offset:5120
    ds_read_b128 v[76:79], v6 offset:23552
    ds_read_b128 v[80:83], v6 offset:41984
    s_waitcnt vmcnt(16)
    v_mfma_f32_16x16x32_bf16 v[24:27], a[72:75], v[96:99], v[24:27]
    v_mfma_f32_16x16x32_bf16 v[28:31], a[76:79], v[96:99], v[28:31]
    s_waitcnt lgkmcnt(5)
    v_mfma_f32_16x16x32_bf16 v[48:51], a[72:75], v[84:87], v[48:51]
    v_mfma_f32_16x16x32_bf16 v[52:55], a[76:79], v[84:87], v[52:55]
    s_waitcnt lgkmcnt(4)
    v_mfma_f32_16x16x32_bf16 v[56:59], a[72:75], v[88:91], v[56:59]
    v_mfma_f32_16x16x32_bf16 v[60:63], a[76:79], v[88:91], v[60:63]
    s_waitcnt lgkmcnt(3)
    v_mfma_f32_16x16x32_bf16 v[32:35], a[72:75], v[92:95], v[32:35]
    v_mfma_f32_16x16x32_bf16 v[36:39], a[76:79], v[92:95], v[36:39]
    ds_read_b128 v[84:87], v7 offset:5120
    ds_read_b128 v[88:91], v7 offset:23552
    ds_read_b128 v[92:95], v7 offset:41984
    s_waitcnt vmcnt(14)
    v_mfma_f32_16x16x32_bf16 v[24:27], a[80:83], v[96:99], v[24:27]
    v_mfma_f32_16x16x32_bf16 v[28:31], a[84:87], v[96:99], v[28:31]
    s_waitcnt lgkmcnt(5)
    v_mfma_f32_16x16x32_bf16 v[48:51], a[80:83], v[72:75], v[48:51]
    v_mfma_f32_16x16x32_bf16 v[52:55], a[84:87], v[72:75], v[52:55]
    s_waitcnt lgkmcnt(4)
    v_mfma_f32_16x16x32_bf16 v[56:59], a[80:83], v[76:79], v[56:59]
    v_mfma_f32_16x16x32_bf16 v[60:63], a[84:87], v[76:79], v[60:63]
    s_waitcnt lgkmcnt(3)
    v_mfma_f32_16x16x32_bf16 v[32:35], a[80:83], v[80:83], v[32:35]
    v_mfma_f32_16x16x32_bf16 v[36:39], a[84:87], v[80:83], v[36:39]
    ds_read_b128 v[72:75], v6 offset:6144
    ds_read_b128 v[76:79], v6 offset:24576
    ds_read_b128 v[80:83], v6 offset:43008
    s_waitcnt vmcnt(12)
    v_mfma_f32_16x16x32_bf16 v[24:27], a[88:91], v[96:99], v[24:27]
    v_mfma_f32_16x16x32_bf16 v[28:31], a[92:95], v[96:99], v[28:31]
    s_waitcnt lgkmcnt(5)
    v_mfma_f32_16x16x32_bf16 v[48:51], a[88:91], v[84:87], v[48:51]
    v_mfma_f32_16x16x32_bf16 v[52:55], a[92:95], v[84:87], v[52:55]
    s_waitcnt lgkmcnt(4)
    v_mfma_f32_16x16x32_bf16 v[56:59], a[88:91], v[88:91], v[56:59]
    v_mfma_f32_16x16x32_bf16 v[60:63], a[92:95], v[88:91], v[60:63]
    s_waitcnt lgkmcnt(3)
    v_mfma_f32_16x16x32_bf16 v[32:35], a[88:91], v[92:95], v[32:35]
    v_mfma_f32_16x16x32_bf16 v[36:39], a[92:95], v[92:95], v[36:39]
    ds_read_b128 v[84:87], v7 offset:6144
    ds_read_b128 v[88:91], v7 offset:24576
    ds_read_b128 v[92:95], v7 offset:43008
    s_waitcnt vmcnt(10)
    v_mfma_f32_16x16x32_bf16 v[24:27], a[96:99], v[96:99], v[24:27]
    v_mfma_f32_16x16x32_bf16 v[28:31], a[100:103], v[96:99], v[28:31]
    s_waitcnt lgkmcnt(5)
    v_mfma_f32_16x16x32_bf16 v[48:51], a[96:99], v[72:75], v[48:51]
    v_mfma_f32_16x16x32_bf16 v[52:55], a[100:103], v[72:75], v[52:55]
    s_waitcnt lgkmcnt(4)
    v_mfma_f32_16x16x32_bf16 v[56:59], a[96:99], v[76:79], v[56:59]
    v_mfma_f32_16x16x32_bf16 v[60:63], a[100:103], v[76:79], v[60:63]
    s_waitcnt lgkmcnt(3)
    v_mfma_f32_16x16x32_bf16 v[32:35], a[96:99], v[80:83], v[32:35]
    v_mfma_f32_16x16x32_bf16 v[36:39], a[100:103], v[80:83], v[36:39]
    ds_read_b128 v[72:75], v6 offset:7168
    ds_read_b128 v[76:79], v6 offset:25600
    ds_read_b128 v[80:83], v6 offset:44032
    s_waitcnt vmcnt(8)
    v_mfma_f32_16x16x32_bf16 v[24:27], a[104:107], v[96:99], v[24:27]
    v_mfma_f32_16x16x32_bf16 v[28:31], a[108:111], v[96:99], v[28:31]
    s_waitcnt lgkmcnt(5)
    v_mfma_f32_16x16x32_bf16 v[48:51], a[104:107], v[84:87], v[48:51]
    v_mfma_f32_16x16x32_bf16 v[52:55], a[108:111], v[84:87], v[52:55]
    s_waitcnt lgkmcnt(4)
    v_mfma_f32_16x16x32_bf16 v[56:59], a[104:107], v[88:91], v[56:59]
    v_mfma_f32_16x16x32_bf16 v[60:63], a[108:111], v[88:91], v[60:63]
    s_waitcnt lgkmcnt(3)
    v_mfma_f32_16x16x32_bf16 v[32:35], a[104:107], v[92:95], v[32:35]
    v_mfma_f32_16x16x32_bf16 v[36:39], a[108:111], v[92:95], v[36:39]
    ds_read_b128 v[84:87], v7 offset:7168
    ds_read_b128 v[88:91], v7 offset:25600
    ds_read_b128 v[92:95], v7 offset:44032
    s_waitcnt vmcnt(6)
    v_mfma_f32_16x16x32_bf16 v[24:27], a[112:115], v[96:99], v[24:27]
    v_mfma_f32_16x16x32_bf16 v[28:31], a[116:119], v[96:99], v[28:31]
    s_waitcnt lgkmcnt(5)
    v_mfma_f32_16x16x32_bf16 v[48:51], a[112:115], v[72:75], v[48:51]
    v_mfma_f32_16x16x32_bf16 v[52:55], a[116:119], v[72:75], v[52:55]
    s_waitcnt lgkmcnt(4)
    v_mfma_f32_16x16x32_bf16 v[56:59], a[112:115], v[76:79], v[56:59]
    v_mfma_f32_16x16x32_bf16 v[60:63], a[116:119], v[76:79], v[60:63]
    s_waitcnt lgkmcnt(3)
    v_mfma_f32_16x16x32_bf16 v[32:35], a[112:115], v[80:83], v[32:35]
    v_mfma_f32_16x16x32_bf16 v[36:39], a[116:119], v[80:83], v[36:39]
    ds_read_b128 v[72:75], v6 offset:8192
    ds_read_b128 v[76:79], v6 offset:26624
    ds_read_b128 v[80:83], v6 offset:45056
    s_waitcnt vmcnt(4)
    v_mfma_f32_16x16x32_bf16 v[24:27], a[120:123], v[96:99], v[24:27]
    v_mfma_f32_16x16x32_bf16 v[28:31], a[124:127], v[96:99], v[28:31]
    s_waitcnt lgkmcnt(5)
    v_mfma_f32_16x16x32_bf16 v[48:51], a[120:123], v[84:87], v[48:51]
    v_mfma_f32_16x16x32_bf16 v[52:55], a[124:127], v[84:87], v[52:55]
    s_waitcnt lgkmcnt(4)
    v_mfma_f32_16x16x32_bf16 v[56:59], a[120:123], v[88:91], v[56:59]
    v_mfma_f32_16x16x32_bf16 v[60:63], a[124:127], v[88:91], v[60:63]
    s_waitcnt lgkmcnt(3)
    v_mfma_f32_16x16x32_bf16 v[32:35], a[120:123], v[92:95], v[32:35]
    v_mfma_f32_16x16x32_bf16 v[36:39], a[124:127], v[92:95], v[36:39]
    ds_read_b128 v[84:87], v7 offset:8192
    ds_read_b128 v[88:91], v7 offset:26624
    ds_read_b128 v[92:95], v7 offset:45056
    s_waitcnt vmcnt(2)
    v_mfma_f32_16x16x32_bf16 v[24:27], a[128:131], v[96:99], v[24:27]
    v_mfma_f32_16x16x32_bf16 v[28:31], a[132:135], v[96:99], v[28:31]
    s_waitcnt lgkmcnt(5)
    v_mfma_f32_16x16x32_bf16 v[48:51], a[128:131], v[72:75], v[48:51]
    v_mfma_f32_16x16x32_bf16 v[52:55], a[132:135], v[72:75], v[52:55]
    s_waitcnt lgkmcnt(4)
    v_mfma_f32_16x16x32_bf16 v[56:59], a[128:131], v[76:79], v[56:59]
    v_mfma_f32_16x16x32_bf16 v[60:63], a[132:135], v[76:79], v[60:63]
    s_waitcnt lgkmcnt(3)
    v_mfma_f32_16x16x32_bf16 v[32:35], a[128:131], v[80:83], v[32:35]
    v_mfma_f32_16x16x32_bf16 v[36:39], a[132:135], v[80:83], v[36:39]
    s_waitcnt vmcnt(0)
    v_mfma_f32_16x16x32_bf16 v[24:27], a[136:139], v[96:99], v[24:27]
    v_mfma_f32_16x16x32_bf16 v[28:31], a[140:143], v[96:99], v[28:31]
    s_waitcnt lgkmcnt(2)
    v_mfma_f32_16x16x32_bf16 v[48:51], a[136:139], v[84:87], v[48:51]
    v_mfma_f32_16x16x32_bf16 v[52:55], a[140:143], v[84:87], v[52:55]
    s_waitcnt lgkmcnt(1)
    v_mfma_f32_16x16x32_bf16 v[56:59], a[136:139], v[88:91], v[56:59]
    v_mfma_f32_16x16x32_bf16 v[60:63], a[140:143], v[88:91], v[60:63]
    s_waitcnt lgkmcnt(0)
    v_mfma_f32_16x16x32_bf16 v[32:35], a[136:139], v[92:95], v[32:35]
    v_mfma_f32_16x16x32_bf16 v[36:39], a[140:143], v[92:95], v[36:39]
    ds_write_b8 v11, v12 offset:132
    ds_write_b8 v11, v12 offset:136
    ds_write_b8 v11, v12 offset:140
L_tok83:
    ds_read_b64 v[18:19], v1
    s_waitcnt lgkmcnt(0)
    v_readfirstlane_b32 s40, v18
    v_readfirstlane_b32 s41, v19
    s_cmp_eq_u32 s40, 2
    s_cbranch_scc1 L5_fallback
    s_cmp_eq_u32 s40, 1
    s_cbranch_scc1 L_tokx84
    s_cmp_eq_u32 s28, 0
    s_cbranch_scc1 L_tokx84
    s_sub_u32 s28, s28, 1
    s_sleep 1
    s_branch L_tok83
L_tokx84:
L_lw85:
    ds_read_b32 v18, v1 offset:68
    s_waitcnt lgkmcnt(0)
    v_readfirstlane_b32 s40, v18
    s_nop 0
    s_cmp_ge_u32 s40, 1
    s_cbranch_scc1 L_lwx86
    s_cmp_eq_u32 s28, 0
    s_cbranch_scc1 L_lwx86
    s_sub_u32 s28, s28, 1
    s_branch L_lw85
L_lwx86:
    ds_read_b128 v[20:23], v13 offset:1280
    s_waitcnt lgkmcnt(0)
    v_fma_f32 v64, v24, v20, v48
    v_fma_f32 v65, v25, v20, v49
    v_fma_f32 v66, v26, v20, v50
    v_fma_f32 v67, v27, v20, v51
    v_mul_f32 v64, v64, v21
    v_mul_f32 v65, v65, v21
    v_mul_f32 v66, v66, v21
    v_mul_f32 v67, v67, v21
    v_cvt_pk_bf16_f32 v64, v64, v65
    v_cvt_pk_bf16_f32 v65, v66, v67
    v_fma_f32 v68, v28, v20, v52
    v_fma_f32 v69, v29, v20, v53
    v_fma_f32 v70, v30, v20, v54
    v_fma_f32 v71, v31, v20, v55
    v_mul_f32 v68, v68, v21
    v_mul_f32 v69, v69, v21
    v_mul_f32 v70, v70, v21
    v_mul_f32 v71, v71, v21
    v_cvt_pk_bf16_f32 v68, v68, v69
    v_cvt_pk_bf16_f32 v69, v70, v71
    v_add_u32 v16, v14, v22
    v_add_u32 v17, v15, v22
    ds_write_b64 v16, v[64:65]
    ds_write_b64 v17, v[68:69]
    ds_write_b8 v11, v12 offset:212
    ds_read_b128 v[20:23], v13 offset:1536
    s_waitcnt lgkmcnt(0)
    v_fma_f32 v64, v24, v20, v56
    v_fma_f32 v65, v25, v20, v57
    v_fma_f32 v66, v26, v20, v58
    v_fma_f32 v67, v27, v20, v59
    v_mul_f32 v64, v64, v21
    v_mul_f32 v65, v65, v21
    v_mul_f32 v66, v66, v21
    v_mul_f32 v67, v67, v21
    v_cvt_pk_bf16_f32 v64, v64, v65
    v_cvt_pk_bf16_f32 v65, v66, v67
    v_fma_f32 v68, v28, v20, v60
    v_fma_f32 v69, v29, v20, v61
    v_fma_f32 v70, v30, v20, v62
    v_fma_f32 v71, v31, v20, v63
    v_mul_f32 v68, v68, v21
    v_mul_f32 v69, v69, v21
    v_mul_f32 v70, v70, v21
    v_mul_f32 v71, v71, v21
    v_cvt_pk_bf16_f32 v68, v68, v69
    v_cvt_pk_bf16_f32 v69, v70, v71
    v_add_u32 v16, v14, v22
    v_add_u32 v17, v15, v22
    ds_write_b64 v16, v[64:65]
    ds_write_b64 v17, v[68:69]
    ds_write_b8 v11, v12 offset:216
    v_xor_b32 v13, 512, v13
    s_mov_b32 s32, 3
    s_or_b32 s40, s21, s3
    s_cmp_eq_u32 s40, 0
    s_cselect_b32 s36, 0, 99
    ds_read_b128 v[20:23], v13 offset:0
    s_waitcnt lgkmcnt(0)
    v_fma_f32 v64, v24, v20, v32
    v_fma_f32 v65, v25, v20, v33
    v_fma_f32 v66, v26, v20, v34
    v_fma_f32 v67, v27, v20, v35
    v_mul_f32 v64, v64, v21
    v_mul_f32 v65, v65, v21
    v_mul_f32 v66, v66, v21
    v_mul_f32 v67, v67, v21
    v_cvt_pk_bf16_f32 v64, v64, v65
    v_cvt_pk_bf16_f32 v65, v66, v67
    v_fma_f32 v68, v28, v20, v36
    v_fma_f32 v69, v29, v20, v37
    v_fma_f32 v70, v30, v20, v38
    v_fma_f32 v71, v31, v20, v39
    v_mul_f32 v68, v68, v21
    v_mul_f32 v69, v69, v21
    v_mul_f32 v70, v70, v21
    v_mul_f32 v71, v71, v21
    v_cvt_pk_bf16_f32 v68, v68, v69
    v_cvt_pk_bf16_f32 v69, v70, v71
    v_add_u32 v16, v14, v22
    v_add_u32 v17, v15, v22
    ds_write_b64 v16, v[64:65]
    ds_write_b64 v17, v[68:69]
    ds_write_b8 v11, v12 offset:220
L_xr87:
    ds_read_b32 v19, v10 offset:64
    s_waitcnt lgkmcnt(0)
    v_readfirstlane_b32 s37, v19
    s_nop 0
    s_cmp_lg_u32 s37, 0
    s_cbranch_scc1 L_xrx88
    s_cmp_eq_u32 s28, 0
    s_cbranch_scc1 L_xrx88
    s_sub_u32 s28, s28, 1
    s_branch L_xr87
L_xrx88:
    v_add_u32 v8, v4, v19
    v_add_u32 v9, v5, v19
    ds_read_b128 v[72:75], v8 offset:0
    ds_read_b128 v[76:79], v9 offset:0
    ds_read_b128 v[80:83], v8 offset:1024
    ds_read_b128 v[84:87], v9 offset:1024
    ds_read_b128 v[88:91], v8 offset:2048
    ds_read_b128 v[92:95], v9 offset:2048
    s_waitcnt lgkmcnt(0)
L5_qo:
    s_waitcnt lgkmcnt(4)
    v_mfma_f32_16x16x32_bf16 v[40:43], a[0:3], v[72:75], 0
    ds_read_b32 v18, v10 offset:300
    ds_read_b128 v[20:23], v13 offset:0
    v_mfma_f32_16x16x32_bf16 v[44:47], a[4:7], v[72:75], 0
    ds_read_b128 v[72:75], v8 offset:3072
    v_mfma_f32_16x16x32_bf16 v[40:43], a[8:11], v[76:79], v[40:43]
    v_mfma_f32_16x16x32_bf16 v[44:47], a[12:15], v[76:79], v[44:47]
    ds_read_b128 v[76:79], v9 offset:3072
    s_waitcnt lgkmcnt(6)
    v_mfma_f32_16x16x32_bf16 v[40:43], a[16:19], v[80:83], v[40:43]
    s_waitcnt lgkmcnt(2)
    v_readfirstlane_b32 s40, v18
    v_mfma_f32_16x16x32_bf16 v[44:47], a[20:23], v[80:83], v[44:47]
    ds_read_b128 v[80:83], v8 offset:4096
    v_fma_f32 v64, v24, v20, v32
    s_cmp_lt_u32 s40, 2
    v_mfma_f32_16x16x32_bf16 v[40:43], a[24:27], v[84:87], v[40:43]
    s_cbranch_scc1 L_frs89
L_frb90:
    v_fma_f32 v65, v25, v20, v33
    v_mfma_f32_16x16x32_bf16 v[44:47], a[28:31], v[84:87], v[44:47]
    ds_read_b128 v[84:87], v9 offset:4096
    v_fma_f32 v66, v26, v20, v34
    v_fma_f32 v67, v27, v20, v35
    v_mfma_f32_16x16x32_bf16 v[40:43], a[32:35], v[88:91], v[40:43]
    v_mul_f32 v64, v64, v21
    v_mul_f32 v65, v65, v21
    v_mfma_f32_16x16x32_bf16 v[44:47], a[36:39], v[88:91], v[44:47]
    ds_read_b128 v[88:91], v8 offset:5120
    v_mul_f32 v66, v66, v21
    v_mfma_f32_16x16x32_bf16 v[40:43], a[40:43], v[92:95], v[40:43]
    v_mul_f32 v67, v67, v21
    v_cvt_pk_bf16_f32 v64, v64, v65
    v_mfma_f32_16x16x32_bf16 v[44:47], a[44:47], v[92:95], v[44:47]
    ds_read_b128 v[92:95], v9 offset:5120
    v_cvt_pk_bf16_f32 v65, v66, v67
    s_waitcnt lgkmcnt(4)
    v_mfma_f32_16x16x32_bf16 v[40:43], a[48:51], v[72:75], v[40:43]
    v_fma_f32 v68, v28, v20, v36
    v_fma_f32 v69, v29, v20, v37
    v_mfma_f32_16x16x32_bf16 v[44:47], a[52:55], v[72:75], v[44:47]
    ds_read_b128 v[72:75], v8 offset:6144
    v_fma_f32 v70, v30, v20, v38
    v_mfma_f32_16x16x32_bf16 v[40:43], a[56:59], v[76:79], v[40:43]
    v_fma_f32 v71, v31, v20, v39
    v_mul_f32 v68, v68, v21
    v_mfma_f32_16x16x32_bf16 v[44:47], a[60:63], v[76:79], v[44:47]
    ds_read_b128 v[76:79], v9 offset:6144
    v_mul_f32 v69, v69, v21
    s_waitcnt lgkmcnt(4)
    v_mfma_f32_16x16x32_bf16 v[40:43], a[64:67], v[80:83], v[40:43]
    v_mul_f32 v70, v70, v21
    v_mul_f32 v71, v71, v21
    v_mfma_f32_16x16x32_bf16 v[44:47], a[68:71], v[80:83], v[44:47]
    ds_read_b128 v[80:83], v8 offset:7168
    v_cvt_pk_bf16_f32 v68, v68, v69
    ds_read_b32 v19, v10 offset:68
    v_mfma_f32_16x16x32_bf16 v[40:43], a[72:75], v[84:87], v[40:43]
    v_cvt_pk_bf16_f32 v69, v70, v71
    v_add_u32 v16, v14, v22
    v_mfma_f32_16x16x32_bf16 v[44:47], a[76:79], v[84:87], v[44:47]
    ds_read_b128 v[84:87], v9 offset:7168
    v_add_u32 v17, v15, v22
    s_waitcnt lgkmcnt(5)
    v_mfma_f32_16x16x32_bf16 v[40:43], a[80:83], v[88:91], v[40:43]
    ds_write_b64 v16, v[64:65]
    ds_write_b64 v17, v[68:69]
    v_mfma_f32_16x16x32_bf16 v[44:47], a[84:87], v[88:91], v[44:47]
    ds_read_b128 v[88:91], v8 offset:8192
    ds_write_b8 v11, v12 offset:220
    v_mfma_f32_16x16x32_bf16 v[40:43], a[88:91], v[92:95], v[40:43]
    s_waitcnt lgkmcnt(5)
    v_add_u32 v6, v4, v19
    v_mfma_f32_16x16x32_bf16 v[44:47], a[92:95], v[92:95], v[44:47]
    ds_read_b128 v[92:95], v9 offset:8192
    v_add_u32 v7, v5, v19
    v_readfirstlane_b32 s37, v19
    v_mfma_f32_16x16x32_bf16 v[40:43], a[96:99], v[72:75], v[40:43]
    ds_write_b8 v11, v12 offset:144
    v_mfma_f32_16x16x32_bf16 v[44:47], a[100:103], v[72:75], v[44:47]
    ds_read_b128 v[72:75], v6 offset:0
    v_mfma_f32_16x16x32_bf16 v[40:43], a[104:107], v[76:79], v[40:43]
    v_mfma_f32_16x16x32_bf16 v[44:47], a[108:111], v[76:79], v[44:47]
    ds_read_b128 v[76:79], v7 offset:0
    s_waitcnt lgkmcnt(8)
    v_mfma_f32_16x16x32_bf16 v[40:43], a[112:115], v[80:83], v[40:43]
    v_mfma_f32_16x16x32_bf16 v[44:47], a[116:119], v[80:83], v[44:47]
    ds_read_b128 v[80:83], v6 offset:1024
    v_mfma_f32_16x16x32_bf16 v[40:43], a[120:123], v[84:87], v[40:43]
    v_mfma_f32_16x16x32_bf16 v[44:47], a[124:127], v[84:87], v[44:47]
    ds_read_b128 v[84:87], v7 offset:1024
    s_waitcnt lgkmcnt(5)
    v_mfma_f32_16x16x32_bf16 v[40:43], a[128:131], v[88:91], v[40:43]
    v_mfma_f32_16x16x32_bf16 v[44:47], a[132:135], v[88:91], v[44:47]
    ds_read_b128 v[88:91], v6 offset:2048
    v_mfma_f32_16x16x32_bf16 v[40:43], a[136:139], v[92:95], v[40:43]
    v_mfma_f32_16x16x32_bf16 v[44:47], a[140:143], v[92:95], v[44:47]
    ds_read_b128 v[92:95], v7 offset:2048
    s_cmp_eq_u32 s37, 0
    s_cbranch_scc1 L5_qo_slow
L5_qe:
    s_waitcnt lgkmcnt(4)
    v_mfma_f32_16x16x32_bf16 v[32:35], a[0:3], v[72:75], 0
    ds_read_b32 v18, v10 offset:304
    ds_read_b128 v[20:23], v13 offset:256
    v_mfma_f32_16x16x32_bf16 v[36:39], a[4:7], v[72:75], 0
    ds_read_b128 v[72:75], v6 offset:3072
    v_mfma_f32_16x16x32_bf16 v[32:35], a[8:11], v[76:79], v[32:35]
    v_mfma_f32_16x16x32_bf16 v[36:39], a[12:15], v[76:79], v[36:39]
    ds_read_b128 v[76:79], v7 offset:3072
    s_waitcnt lgkmcnt(6)
    v_mfma_f32_16x16x32_bf16 v[32:35], a[16:19], v[80:83], v[32:35]
    s_waitcnt lgkmcnt(2)
    v_readfirstlane_b32 s40, v18
    v_mfma_f32_16x16x32_bf16 v[36:39], a[20:23], v[80:83], v[36:39]
    ds_read_b128 v[80:83], v6 offset:4096
    v_fma_f32 v64, v24, v20, v40
    s_cmp_lt_u32 s40, 2
    v_mfma_f32_16x16x32_bf16 v[32:35], a[24:27], v[84:87], v[32:35]
    s_cbranch_scc1 L_frs91
L_frb92:
    v_fma_f32 v65, v25, v20, v41
    v_mfma_f32_16x16x32_bf16 v[36:39], a[28:31], v[84:87], v[36:39]
    ds_read_b128 v[84:87], v7 offset:4096
    v_fma_f32 v66, v26, v20, v42
    v_fma_f32 v67, v27, v20, v43
    v_mfma_f32_16x16x32_bf16 v[32:35], a[32:35], v[88:91], v[32:35]
    v_mul_f32 v64, v64, v21
    v_mul_f32 v65, v65, v21
    v_mfma_f32_16x16x32_bf16 v[36:39], a[36:39], v[88:91], v[36:39]
    ds_read_b128 v[88:91], v6 offset:5120
    v_mul_f32 v66, v66, v21
    v_mfma_f32_16x16x32_bf16 v[32:35], a[40:43], v[92:95], v[32:35]
    v_mul_f32 v67, v67, v21
    v_cvt_pk_bf16_f32 v64, v64, v65
    v_mfma_f32_16x16x32_bf16 v[36:39], a[44:47], v[92:95], v[36:39]
    ds_read_b128 v[92:95], v7 offset:5120
    v_cvt_pk_bf16_f32 v65, v66, v67
    s_waitcnt lgkmcnt(4)
    v_mfma_f32_16x16x32_bf16 v[32:35], a[48:51], v[72:75], v[32:35]
    v_fma_f32 v68, v28, v20, v44
    v_fma_f32 v69, v29, v20, v45
    v_mfma_f32_16x16x32_bf16 v[36:39], a[52:55], v[72:75], v[36:39]
    ds_read_b128 v[72:75], v6 offset:6144
    v_fma_f32 v70, v30, v20, v46
    v_mfma_f32_16x16x32_bf16 v[32:35], a[56:59], v[76:79], v[32:35]
    v_fma_f32 v71, v31, v20, v47
    v_mul_f32 v68, v68, v21
    v_mfma_f32_16x16x32_bf16 v[36:39], a[60:63], v[76:79], v[36:39]
    ds_read_b128 v[76:79], v7 offset:6144
    v_mul_f32 v69, v69, v21
    s_waitcnt lgkmcnt(4)
    v_mfma_f32_16x16x32_bf16 v[32:35], a[64:67], v[80:83], v[32:35]
    v_mul_f32 v70, v70, v21
    v_mul_f32 v71, v71, v21
    v_mfma_f32_16x16x32_bf16 v[36:39], a[68:71], v[80:83], v[36:39]
    ds_read_b128 v[80:83], v6 offset:7168
    v_cvt_pk_bf16_f32 v68, v68, v69
    ds_read_b32 v19, v10 offset:72
    v_mfma_f32_16x16x32_bf16 v[32:35], a[72:75], v[84:87], v[32:35]
    v_cvt_pk_bf16_f32 v69, v70, v71
    v_add_u32 v16, v14, v22
    v_mfma_f32_16x16x32_bf16 v[36:39], a[76:79], v[84:87], v[36:39]
    ds_read_b128 v[84:87], v7 offset:7168
    v_add_u32 v17, v15, v22
    s_waitcnt lgkmcnt(5)
    v_mfma_f32_16x16x32_bf16 v[32:35], a[80:83], v[88:91], v[32:35]
    ds_write_b64 v16, v[64:65]
    ds_write_b64 v17, v[68:69]
    v_mfma_f32_16x16x32_bf16 v[36:39], a[84:87], v[88:91], v[36:39]
    ds_read_b128 v[88:91], v6 offset:8192
    ds_write_b8 v11, v12 offset:224
    v_mfma_f32_16x16x32_bf16 v[32:35], a[88:91], v[92:95], v[32:35]
    s_waitcnt lgkmcnt(5)
    v_add_u32 v8, v4, v19
    v_mfma_f32_16x16x32_bf16 v[36:39], a[92:95], v[92:95], v[36:39]
    ds_read_b128 v[92:95], v7 offset:8192
    v_add_u32 v9, v5, v19
    v_readfirstlane_b32 s37, v19
    v_mfma_f32_16x16x32_bf16 v[32:35], a[96:99], v[72:75], v[32:35]
    ds_write_b8 v11, v12 offset:148
    v_mfma_f32_16x16x32_bf16 v[36:39], a[100:103], v[72:75], v[36:39]
    ds_read_b128 v[72:75], v8 offset:0
    v_mfma_f32_16x16x32_bf16 v[32:35], a[104:107], v[76:79], v[32:35]
    v_mfma_f32_16x16x32_bf16 v[36:39], a[108:111], v[76:79], v[36:39]
    ds_read_b128 v[76:79], v9 offset:0
    s_waitcnt lgkmcnt(8)
    v_mfma_f32_16x16x32_bf16 v[32:35], a[112:115], v[80:83], v[32:35]
    v_xor_b32 v13, 512, v13
    v_add_u32 v10, 8, v10
    v_mfma_f32_16x16x32_bf16 v[36:39], a[116:119], v[80:83], v[36:39]
    ds_read_b128 v[80:83], v8 offset:1024
    v_add_u32 v11, 8, v11
    v_mfma_f32_16x16x32_bf16 v[32:35], a[120:123], v[84:87], v[32:35]
    v_mfma_f32_16x16x32_bf16 v[36:39], a[124:127], v[84:87], v[36:39]
    ds_read_b128 v[84:87], v9 offset:1024
    s_waitcnt lgkmcnt(5)
    v_mfma_f32_16x16x32_bf16 v[32:35], a[128:131], v[88:91], v[32:35]
    v_mfma_f32_16x16x32_bf16 v[36:39], a[132:135], v[88:91], v[36:39]
    ds_read_b128 v[88:91], v8 offset:2048
    v_mfma_f32_16x16x32_bf16 v[32:35], a[136:139], v[92:95], v[32:35]
    v_mfma_f32_16x16x32_bf16 v[36:39], a[140:143], v[92:95], v[36:39]
    ds_read_b128 v[92:95], v9 offset:2048
    s_add_u32 s32, s32, 2
    s_cmp_lg_u32 s37, 0
    s_cbranch_scc1 L5_qo
    ds_read_b128 v[20:23], v13 offset:0
L_fr93:
    ds_read_b32 v18, v10 offset:300
    s_waitcnt lgkmcnt(0)
    v_readfirstlane_b32 s40, v18
    s_nop 0
    s_cmp_ge_u32 s40, 2
    s_cbranch_scc1 L_frx94
    s_cmp_eq_u32 s28, 0
    s_cbranch_scc1 L_frx94
    s_sub_u32 s28, s28, 1
    s_branch L_fr93
L_frx94:
    v_fma_f32 v64, v24, v20, v32
    v_fma_f32 v65, v25, v20, v33
    v_fma_f32 v66, v26, v20, v34
    v_fma_f32 v67, v27, v20, v35
    v_mul_f32 v64, v64, v21
    v_mul_f32 v65, v65, v21
    v_mul_f32 v66, v66, v21
    v_mul_f32 v67, v67, v21
    v_cvt_pk_bf16_f32 v64, v64, v65
    v_cvt_pk_bf16_f32 v65, v66, v67
    v_fma_f32 v68, v28, v20, v36
    v_fma_f32 v69, v29, v20, v37
    v_fma_f32 v70, v30, v20, v38
    v_fma_f32 v71, v31, v20, v39
    v_mul_f32 v68, v68, v21
    v_mul_f32 v69, v69, v21
    v_mul_f32 v70, v70, v21
    v_mul_f32 v71, v71, v21
    v_cvt_pk_bf16_f32 v68, v68, v69
    v_cvt_pk_bf16_f32 v69, v70, v71
    v_add_u32 v16, v14, v22
    v_add_u32 v17, v15, v22
    ds_write_b64 v16, v[64:65]
    ds_write_b64 v17, v[68:69]
    ds_write_b8 v11, v12 offset:220
L_xr95:
    ds_read_b32 v19, v10 offset:64
    s_waitcnt lgkmcnt(0)
    v_readfirstlane_b32 s37, v19
    s_nop 0
    s_cmp_lg_u32 s37, 0
    s_cbranch_scc1 L_xrx96
    s_cmp_eq_u32 s28, 0
    s_cbranch_scc1 L_xrx96
    s_sub_u32 s28, s28, 1
    s_branch L_xr95
L_xrx96:
    v_add_u32 v8, v4, v19
    v_add_u32 v9, v5, v19
    ds_read_b128 v[72:75], v8 offset:0
    ds_read_b128 v[76:79], v9 offset:0
    ds_read_b128 v[80:83], v8 offset:1024
    ds_read_b128 v[84:87], v9 offset:1024
    ds_read_b128 v[88:91], v8 offset:2048
    ds_read_b128 v[92:95], v9 offset:2048
    s_waitcnt lgkmcnt(0)
    s_branch L5_qo
L5_qo_slow:
    ds_read_b128 v[20:23], v13 offset:256
L_fr97:
    ds_read_b32 v18, v10 offset:304
    s_waitcnt lgkmcnt(0)
    v_readfirstlane_b32 s40, v18
    s_nop 0
    s_cmp_ge_u32 s40, 2
    s_cbranch_scc1 L_frx98
    s_cmp_eq_u32 s28, 0
    s_cbranch_scc1 L_frx98
    s_sub_u32 s28, s28, 1
    s_branch L_fr97
L_frx98:
    v_fma_f32 v64, v24, v20, v40
    v_fma_f32 v65, v25, v20, v41
    v_fma_f32 v66, v26, v20, v42
    v_fma_f32 v67, v27, v20, v43
    v_mul_f32 v64, v64, v21
    v_mul_f32 v65, v65, v21
    v_mul_f32 v66, v66, v21
    v_mul_f32 v67, v67, v21
    v_cvt_pk_bf16_f32 v64, v64, v65
    v_cvt_pk_bf16_f32 v65, v66, v67
    v_fma_f32 v68, v28, v20, v44
    v_fma_f32 v69, v29, v20, v45
    v_fma_f32 v70, v30, v20, v46
    v_fma_f32 v71, v31, v20, v47
    v_mul_f32 v68, v68, v21
    v_mul_f32 v69, v69, v21
    v_mul_f32 v70, v70, v21
    v_mul_f32 v71, v71, v21
    v_cvt_pk_bf16_f32 v68, v68, v69
    v_cvt_pk_bf16_f32 v69, v70, v71
    v_add_u32 v16, v14, v22
    v_add_u32 v17, v15, v22
    ds_write_b64 v16, v[64:65]
    ds_write_b64 v17, v[68:69]
    ds_write_b8 v11, v12 offset:224
    s_cmp_ge_u32 s32, 15
    s_cbranch_scc1 L5_qfin
L_xr99:
    ds_read_b32 v19, v10 offset:68
    s_waitcnt lgkmcnt(0)
    v_readfirstlane_b32 s37, v19
    s_nop 0
    s_cmp_lg_u32 s37, 0
    s_cbranch_scc1 L_xrx100
    s_cmp_eq_u32 s28, 0
    s_cbranch_scc1 L_xrx100
    s_sub_u32 s28, s28, 1
    s_branch L_xr99
L_xrx100:
    v_add_u32 v6, v4, v19
    v_add_u32 v7, v5, v19
    ds_read_b128 v[72:75], v6 offset:0
    ds_read_b128 v[76:79], v7 offset:0
    ds_read_b128 v[80:83], v6 offset:1024
    ds_read_b128 v[84:87], v7 offset:1024
    ds_read_b128 v[88:91], v6 offset:2048
    ds_read_b128 v[92:95], v7 offset:2048
    s_waitcnt lgkmcnt(0)
    s_branch L5_qe
L_frs89:
L_fr101:
    ds_read_b32 v18, v10 offset:300
    s_waitcnt lgkmcnt(0)
    v_readfirstlane_b32 s40, v18
    s_nop 0
    s_cmp_ge_u32 s40, 2
    s_cbranch_scc1 L_frx102
    s_cmp_eq_u32 s28, 0
    s_cbranch_scc1 L_frx102
    s_sub_u32 s28, s28, 1
    s_branch L_fr101
L_frx102:
    s_branch L_frb90
L_frs91:
L_fr103:
    ds_read_b32 v18, v10 offset:304
    s_waitcnt lgkmcnt(0)
    v_readfirstlane_b32 s40, v18
    s_nop 0
    s_cmp_ge_u32 s40, 2
    s_cbranch_scc1 L_frx104
    s_cmp_eq_u32 s28, 0
    s_cbranch_scc1 L_frx104
    s_sub_u32 s28, s28, 1
    s_branch L_fr103
L_frx104:
    s_branch L_frb92
L5_qfin:
    s_branch L5_fin
L5_q3:
    s_cmp_ge_u32 s21, 30
    s_cselect_b32 s42, 2, 1
L_lw105:
    ds_read_b32 v8, v1 offset:36
    s_waitcnt lgkmcnt(0)
    v_readfirstlane_b32 s40, v8
    s_nop 0
    s_cmp_ge_u32 s40, s42
    s_cbranch_scc1 L_lwx106
    s_cmp_eq_u32 s28, 0
    s_cbranch_scc1 L_lwx106
    s_sub_u32 s28, s28, 1
    s_sleep 1
    s_branch L_lw105
L_lwx106:
    s_mov_b32 s8, s64
    s_mov_b32 s9, s65
    s_mov_b32 s10, 2359296
    s_mov_b32 s11, 0x00020000
    v_lshrrev_b32 v4, 3, v2
    v_mul_u32_u24 v4, 1152, v4
    v_and_b32 v5, 7, v2
    v_lshl_add_u32 v4, v5, 4, v4
    s_lshl_b32 s40, s20, 5
    s_add_u32 s40, s40, s21
    s_mul_i32 s40, s40, 9216
    buffer_load_dwordx4 v[16:19], v4, s[8:11], s40 offen offset:0
    buffer_load_dwordx4 v[20:23], v4, s[8:11], s40 offen offset:128
    buffer_load_dwordx4 v[24:27], v4, s[8:11], s40 offen offset:256
    buffer_load_dwordx4 v[28:31], v4, s[8:11], s40 offen offset:384
    buffer_load_dwordx4 v[32:35], v4, s[8:11], s40 offen offset:512
    buffer_load_dwordx4 v[36:39], v4, s[8:11], s40 offen offset:640
    buffer_load_dwordx4 v[46:49], v4, s[8:11], s40 offen offset:768
    buffer_load_dwordx4 v[50:53], v4, s[8:11], s40 offen offset:896
    buffer_load_dwordx4 v[54:57], v4, s[8:11], s40 offen offset:1024
    s_waitcnt vmcnt(0)
    s_mov_b32 s40, 0x3f803f80
    v_dot2_f32_bf16 v8, v16, s40, 0
    v_dot2_f32_bf16 v12, v16, v16, 0
    v_dot2_f32_bf16 v9, v17, s40, 0
    v_dot2_f32_bf16 v13, v17, v17, 0
    v_dot2_f32_bf16 v10, v18, s40, 0
    v_dot2_f32_bf16 v14, v18, v18, 0
    v_dot2_f32_bf16 v11, v19, s40, 0
    v_dot2_f32_bf16 v15, v19, v19, 0
    v_dot2_f32_bf16 v8, v20, s40, v8
    v_dot2_f32_bf16 v12, v20, v20, v12
    v_dot2_f32_bf16 v9, v21, s40, v9
    v_dot2_f32_bf16 v13, v21, v21, v13
    v_dot2_f32_bf16 v10, v22, s40, v10
    v_dot2_f32_bf16 v14, v22, v22, v14
    v_dot2_f32_bf16 v11, v23, s40, v11
    v_dot2_f32_bf16 v15, v23, v23, v15
    v_dot2_f32_bf16 v8, v24, s40, v8
    v_dot2_f32_bf16 v12, v24, v24, v12
    v_dot2_f32_bf16 v9, v25, s40, v9
    v_dot2_f32_bf16 v13, v25, v25, v13
    v_dot2_f32_bf16 v10, v26, s40, v10
    v_dot2_f32_bf16 v14, v26, v26, v14
    v_dot2_f32_bf16 v11, v27, s40, v11
    v_dot2_f32_bf16 v15, v27, v27, v15
    v_dot2_f32_bf16 v8, v28, s40, v8
    v_dot2_f32_bf16 v12, v28, v28, v12
    v_dot2_f32_bf16 v9, v29, s40, v9
    v_dot2_f32_bf16 v13, v29, v29, v13
    v_dot2_f32_bf16 v10, v30, s40, v10
    v_dot2_f32_bf16 v14, v30, v30, v14
    v_dot2_f32_bf16 v11, v31, s40, v11
    v_dot2_f32_bf16 v15, v31, v31, v15
    v_dot2_f32_bf16 v8, v32, s40, v8
    v_dot2_f32_bf16 v12, v32, v32, v12
    v_dot2_f32_bf16 v9, v33, s40, v9
    v_dot2_f32_bf16 v13, v33, v33, v13
    v_dot2_f32_bf16 v10, v34, s40, v10
    v_dot2_f32_bf16 v14, v34, v34, v14
    v_dot2_f32_bf16 v11, v35, s40, v11
    v_dot2_f32_bf16 v15, v35, v35, v15
    v_dot2_f32_bf16 v8, v36, s40, v8
    v_dot2_f32_bf16 v12, v36, v36, v12
    v_dot2_f32_bf16 v9, v37, s40, v9
    v_dot2_f32_bf16 v13, v37, v37, v13
    v_dot2_f32_bf16 v10, v38, s40, v10
    v_dot2_f32_bf16 v14, v38, v38, v14
    v_dot2_f32_bf16 v11, v39, s40, v11
    v_dot2_f32_bf16 v15, v39, v39, v15
    v_dot2_f32_bf16 v8, v46, s40, v8
    v_dot2_f32_bf16 v12, v46, v46, v12
    v_dot2_f32_bf16 v9, v47, s40, v9
    v_dot2_f32_bf16 v13, v47, v47, v13
    v_dot2_f32_bf16 v10, v48, s40, v10
    v_dot2_f32_bf16 v14, v48, v48, v14
    v_dot2_f32_bf16 v11, v49, s40, v11
    v_dot2_f32_bf16 v15, v49, v49, v15
    v_dot2_f32_bf16 v8, v50, s40, v8
    v_dot2_f32_bf16 v12, v50, v50, v12
    v_dot2_f32_bf16 v9, v51, s40, v9
    v_dot2_f32_bf16 v13, v51, v51, v13
    v_dot2_f32_bf16 v10, v52, s40, v10
    v_dot2_f32_bf16 v14, v52, v52, v14
    v_dot2_f32_bf16 v11, v53, s40, v11
    v_dot2_f32_bf16 v15, v53, v53, v15
    v_dot2_f32_bf16 v8, v54, s40, v8
    v_dot2_f32_bf16 v12, v54, v54, v12
    v_dot2_f32_bf16 v9, v55, s40, v9
    v_dot2_f32_bf16 v13, v55, v55, v13
    v_dot2_f32_bf16 v10, v56, s40, v10
    v_dot2_f32_bf16 v14, v56, v56, v14
    v_dot2_f32_bf16 v11, v57, s40, v11
    v_dot2_f32_bf16 v15, v57, v57, v15
    v_add_f32 v8, v8, v9
    s_nop 0
    v_add_f32 v10, v10, v11
    v_add_f32 v12, v12, v13
    v_add_f32 v14, v14, v15
    v_add_f32 v8, v8, v10
    v_add_f32 v9, v12, v14
    s_nop 0
    v_add_f32_dpp v8, v8, v8 quad_perm:[1,0,3,2] row_mask:0xf bank_mask:0xf
    v_add_f32_dpp v9, v9, v9 quad_perm:[1,0,3,2] row_mask:0xf bank_mask:0xf
    s_nop 0
    v_add_f32_dpp v8, v8, v8 quad_perm:[2,3,0,1] row_mask:0xf bank_mask:0xf
    v_add_f32_dpp v9, v9, v9 quad_perm:[2,3,0,1] row_mask:0xf bank_mask:0xf
    s_nop 0
    v_add_f32_dpp v8, v8, v8 row_half_mirror row_mask:0xf bank_mask:0xf
    v_add_f32_dpp v9, v9, v9 row_half_mirror row_mask:0xf bank_mask:0xf
    v_and_b32 v11, 7, v2
    v_cmp_eq_u32 vcc, 0, v11
    s_nop 1
    v_cndmask_b32 v8, 0, v8, vcc
    v_cndmask_b32 v9, 0, v9, vcc
    v_lshrrev_b32 v10, 3, v2
    v_and_b32 v12, 1, v10
    v_lshrrev_b32 v10, 1, v10
    v_lshl_add_u32 v10, v12, 3, v10
    v_lshlrev_b32 v10, 6, v10
    v_lshl_add_u32 v10, v11, 3, v10
    s_lshr_b32 s40, s21, 1
    s_lshl_b32 s40, s40, 10
    s_and_b32 s41, s21, 1
    s_lshl_b32 s41, s41, 8
    s_add_u32 s40, s40, s41
    s_add_u32 s40, s40, s26
    s_add_u32 s46, s40, 360448
    buffer_store_dwordx2 v[8:9], v10, s[4:7], s46 offen
    v_and_b32 v18, 7, v2
    v_lshrrev_b32 v19, 4, v2
    v_xor_b32 v4, v18, v19
    v_lshlrev_b32 v4, 4, v4
    v_lshl_add_u32 v4, v18, 7, v4
    v_bfe_u32 v18, v2, 3, 1
    v_mul_u32_u24 v18, 9216, v18
    v_add_u32 v4, v4, v18
    v_xor_b32 v5, 64, v4
    v_add_u32 v6, 82944, v4
    v_add_u32 v7, 82944, v5
    v_mov_b32 v12, 1
    v_add_u32 v10, 12, v1
    v_add_u32 v11, s3, v10
    v_and_b32 v18, 15, v2
    v_lshlrev_b32 v13, 4, v18
    v_add_u32 v13, 160768, v13
    v_mul_u32_u24 v14, 240, v18
    v_mov_b32 v96, 0x3f803f80
    v_mov_b32 v97, 0x3f803f80
    v_mov_b32 v98, 0x3f803f80
    v_mov_b32 v99, 0x3f803f80
    s_mov_b32 s51, 0x01010101
    s_mov_b32 s50, 0
    s_mul_i32 s35, s22, 129024
    v_lshlrev_b32 v18, 3, v19
    v_add_u32 v18, 128, v18
    v_mul_u32_u24 v15, 40, v19
    v_add_u32 v15, 96, v15
    v_cmp_gt_u32 vcc, 32, v2
    s_nop 1
    v_cndmask_b32 v18, v15, v18, vcc
    v_add_u32 v14, v14, v18
    s_add_u32 s35, s35, 20975616
    v_and_b32 v18, 15, v2
    v_cmp_gt_u32 vcc, 12, v18
    v_mov_b32 v15, 0x7fffffff
    s_nop 0
    v_cndmask_b32 v15, v15, v3, vcc
    v_lshrrev_b32 v18, 3, v2
    v_and_b32 v19, 7, v2
    v_xor_b32 v19, v19, v18
    v_mul_u32_u24 v102, 2304, v18
    v_lshl_add_u32 v102, v19, 4, v102
    v_add_u32 v103, 1152, v102
    v_lshrrev_b32 v17, 2, v2
    v_lshlrev_b32 v17, 4, v17
    v_add_u32 v17, 160768, v17
    s_mov_b32 s10, 32768
    s_mov_b32 s11, 0x00020000
    s_lshl_b32 s39, s30, 13
    s_add_u32 s39, s39, s26
    s_add_u32 s39, s39, 367616
    s_movk_i32 s54, 2688
    s_movk_i32 s55, 1792
    s_movk_i32 s56, 896
    s_movk_i32 s57, 0
    s_movk_i32 s58, 3200
    s_movk_i32 s59, 2304
    s_movk_i32 s60, 1408
    s_movk_i32 s61, 512
    s_movk_i32 s62, 3712
    s_mov_b32 s36, 0
    s_mov_b32 s33, 138240
    s_mov_b32 s34, 82944
    s_lshl_b32 s52, s30, 8
    s_add_u32 s52, s52, s27
    s_add_u32 s52, s52, 1280
    v_lshlrev_b32 v109, 2, v2
    s_waitcnt vmcnt(0)
    s_lshl_b32 s40, s21, 2
    s_add_u32 s40, s40, s27
    v_mov_b32 v64, 0
    v_mov_b32 v65, s94
    s_mov_b64 exec, 1
    buffer_store_dword v65, v64, s[4:7], s40 offen offset:128
    s_mov_b64 exec, -1
    s_lshl_b32 s42, s30, 6
    s_add_u32 s42, s42, s27
    s_add_u32 s42, s42, 128
    v_and_b32 v64, 15, v2
    v_lshlrev_b32 v64, 2, v64
L5_xp:
    buffer_load_dword v65, v64, s[4:7], s42 offen sc1
    ds_read_b64 v[66:67], v1
    s_waitcnt vmcnt(0) lgkmcnt(0)
    v_readfirstlane_b32 s40, v66
    v_readfirstlane_b32 s41, v67
    v_cmp_ne_u32 vcc, s94, v65
    s_cmp_eq_u32 s40, 2
    s_cbranch_scc1 L5_fallback
    s_cbranch_vccz L5_xpx
    s_cmp_eq_u32 s28, 0
    s_cbranch_scc1 L5_xpx
    s_sub_u32 s28, s28, 1
    s_branch L5_xp
L5_xpx:
    s_sub_u32 s42, s39, 2048
    buffer_load_dwordx4 v[36:39], v3, s[4:7], s42 offen offset:2048 sc1
    buffer_load_dwordx4 v[40:43], v3, s[4:7], s42 offen offset:1024 sc1
    buffer_load_dwordx4 v[44:47], v3, s[4:7], s42 offen offset:0 sc1
    s_cmp_ge_u32 s50, 12
    s_cbranch_scc1 L_gtx108
L_gt107:
    ds_read_b32 v100, v1 offset:20
    s_waitcnt lgkmcnt(0)
    v_readfirstlane_b32 s50, v100
    s_nop 0
    s_cmp_ge_u32 s50, 12
    s_cbranch_scc1 L_gtx108
    s_cmp_eq_u32 s28, 0
    s_cbranch_scc1 L_gtx108
    s_sub_u32 s28, s28, 1
    s_sleep 1
    s_branch L_gt107
L_gtx108:
    buffer_load_dwordx4 a[0:3], v15, s[4:7], s35 offen offset:0 sc1
    s_add_u32 s35, s35, 7168
    s_cmp_ge_u32 s50, 24
    s_cbranch_scc1 L_gtx110
L_gt109:
    ds_read_b32 v100, v1 offset:20
    s_waitcnt lgkmcnt(0)
    v_readfirstlane_b32 s50, v100
    s_nop 0
    s_cmp_ge_u32 s50, 24
    s_cbranch_scc1 L_gtx110
    s_cmp_eq_u32 s28, 0
    s_cbranch_scc1 L_gtx110
    s_sub_u32 s28, s28, 1
    s_sleep 1
    s_branch L_gt109
L_gtx110:
    buffer_load_dwordx4 a[4:7], v15, s[4:7], s35 offen offset:0 sc1
    s_add_u32 s35, s35, 7168
    s_cmp_ge_u32 s50, 36
    s_cbranch_scc1 L_gtx112
L_gt111:
    ds_read_b32 v100, v1 offset:20
    s_waitcnt lgkmcnt(0)
    v_readfirstlane_b32 s50, v100
    s_nop 0
    s_cmp_ge_u32 s50, 36
    s_cbranch_scc1 L_gtx112
    s_cmp_eq_u32 s28, 0
    s_cbranch_scc1 L_gtx112
    s_sub_u32 s28, s28, 1
    s_sleep 1
    s_branch L_gt111
L_gtx112:
    buffer_load_dwordx4 a[8:11], v15, s[4:7], s35 offen offset:0 sc1
    s_add_u32 s35, s35, 7168
    s_cmp_ge_u32 s50, 48
    s_cbranch_scc1 L_gtx114
L_gt113:
    ds_read_b32 v100, v1 offset:20
    s_waitcnt lgkmcnt(0)
    v_readfirstlane_b32 s50, v100
    s_nop 0
    s_cmp_ge_u32 s50, 48
    s_cbranch_scc1 L_gtx114
    s_cmp_eq_u32 s28, 0
    s_cbranch_scc1 L_gtx114
    s_sub_u32 s28, s28, 1
    s_sleep 1
    s_branch L_gt113
L_gtx114:
    buffer_load_dwordx4 a[12:15], v15, s[4:7], s35 offen offset:0 sc1
    s_add_u32 s35, s35, 7168
    s_cmp_ge_u32 s50, 60
    s_cbranch_scc1 L_gtx116
L_gt115:
    ds_read_b32 v100, v1 offset:20
    s_waitcnt lgkmcnt(0)
    v_readfirstlane_b32 s50, v100
    s_nop 0
    s_cmp_ge_u32 s50, 60
    s_cbranch_scc1 L_gtx116
    s_cmp_eq_u32 s28, 0
    s_cbranch_scc1 L_gtx116
    s_sub_u32 s28, s28, 1
    s_sleep 1
    s_branch L_gt115
L_gtx116:
    buffer_load_dwordx4 a[16:19], v15, s[4:7], s35 offen offset:0 sc1
    s_add_u32 s35, s35, 7168
    s_cmp_ge_u32 s50, 72
    s_cbranch_scc1 L_gtx118
L_gt117:
    ds_read_b32 v100, v1 offset:20
    s_waitcnt lgkmcnt(0)
    v_readfirstlane_b32 s50, v100
    s_nop 0
    s_cmp_ge_u32 s50, 72
    s_cbranch_scc1 L_gtx118
    s_cmp_eq_u32 s28, 0
    s_cbranch_scc1 L_gtx118
    s_sub_u32 s28, s28, 1
    s_sleep 1
    s_branch L_gt117
L_gtx118:
    buffer_load_dwordx4 a[20:23], v15, s[4:7], s35 offen offset:0 sc1
    s_add_u32 s35, s35, 7168
    s_cmp_ge_u32 s50, 84
    s_cbranch_scc1 L_gtx120
L_gt119:
    ds_read_b32 v100, v1 offset:20
    s_waitcnt lgkmcnt(0)
    v_readfirstlane_b32 s50, v100
    s_nop 0
    s_cmp_ge_u32 s50, 84
    s_cbranch_scc1 L_gtx120
    s_cmp_eq_u32 s28, 0
    s_cbranch_scc1 L_gtx120
    s_sub_u32 s28, s28, 1
    s_sleep 1
    s_branch L_gt119
L_gtx120:
    buffer_load_dwordx4 a[24:27], v15, s[4:7], s35 offen offset:0 sc1
    s_add_u32 s35, s35, 7168
    s_cmp_ge_u32 s50, 96
    s_cbranch_scc1 L_gtx122
L_gt121:
    ds_read_b32 v100, v1 offset:20
    s_waitcnt lgkmcnt(0)
    v_readfirstlane_b32 s50, v100
    s_nop 0
    s_cmp_ge_u32 s50, 96
    s_cbranch_scc1 L_gtx122
    s_cmp_eq_u32 s28, 0
    s_cbranch_scc1 L_gtx122
    s_sub_u32 s28, s28, 1
    s_sleep 1
    s_branch L_gt121
L_gtx122:
    buffer_load_dwordx4 a[28:31], v15, s[4:7], s35 offen offset:0 sc1
    s_add_u32 s35, s35, 7168
    s_cmp_ge_u32 s50, 108
    s_cbranch_scc1 L_gtx124
L_gt123:
    ds_read_b32 v100, v1 offset:20
    s_waitcnt lgkmcnt(0)
    v_readfirstlane_b32 s50, v100
    s_nop 0
    s_cmp_ge_u32 s50, 108
    s_cbranch_scc1 L_gtx124
    s_cmp_eq_u32 s28, 0
    s_cbranch_scc1 L_gtx124
    s_sub_u32 s28, s28, 1
    s_sleep 1
    s_branch L_gt123
L_gtx124:
    buffer_load_dwordx4 a[32:35], v15, s[4:7], s35 offen offset:0 sc1
    s_add_u32 s35, s35, 7168
    s_cmp_ge_u32 s50, 120
    s_cbranch_scc1 L_gtx126
L_gt125:
    ds_read_b32 v100, v1 offset:20
    s_waitcnt lgkmcnt(0)
    v_readfirstlane_b32 s50, v100
    s_nop 0
    s_cmp_ge_u32 s50, 120
    s_cbranch_scc1 L_gtx126
    s_cmp_eq_u32 s28, 0
    s_cbranch_scc1 L_gtx126
    s_sub_u32 s28, s28, 1
    s_sleep 1
    s_branch L_gt125
L_gtx126:
    buffer_load_dwordx4 a[36:39], v15, s[4:7], s35 offen offset:0 sc1
    s_add_u32 s35, s35, 7168
    s_cmp_ge_u32 s50, 132
    s_cbranch_scc1 L_gtx128
L_gt127:
    ds_read_b32 v100, v1 offset:20
    s_waitcnt lgkmcnt(0)
    v_readfirstlane_b32 s50, v100
    s_nop 0
    s_cmp_ge_u32 s50, 132
    s_cbranch_scc1 L_gtx128
    s_cmp_eq_u32 s28, 0
    s_cbranch_scc1 L_gtx128
    s_sub_u32 s28, s28, 1
    s_sleep 1
    s_branch L_gt127
L_gtx128:
    buffer_load_dwordx4 a[40:43], v15, s[4:7], s35 offen offset:0 sc1
    s_add_u32 s35, s35, 7168
    s_cmp_ge_u32 s50, 144
    s_cbranch_scc1 L_gtx130
L_gt129:
    ds_read_b32 v100, v1 offset:20
    s_waitcnt lgkmcnt(0)
    v_readfirstlane_b32 s50, v100
    s_nop 0
    s_cmp_ge_u32 s50, 144
    s_cbranch_scc1 L_gtx130
    s_cmp_eq_u32 s28, 0
    s_cbranch_scc1 L_gtx130
    s_sub_u32 s28, s28, 1
    s_sleep 1
    s_branch L_gt129
L_gtx130:
    buffer_load_dwordx4 a[44:47], v15, s[4:7], s35 offen offset:0 sc1
    s_add_u32 s35, s35, 7168
    s_cmp_ge_u32 s50, 156
    s_cbranch_scc1 L_gtx132
L_gt131:
    ds_read_b32 v100, v1 offset:20
    s_waitcnt lgkmcnt(0)
    v_readfirstlane_b32 s50, v100
    s_nop 0
    s_cmp_ge_u32 s50, 156
    s_cbranch_scc1 L_gtx132
    s_cmp_eq_u32 s28, 0
    s_cbranch_scc1 L_gtx132
    s_sub_u32 s28, s28, 1
    s_sleep 1
    s_branch L_gt131
L_gtx132:
    buffer_load_dwordx4 a[48:51], v15, s[4:7], s35 offen offset:0 sc1
    s_add_u32 s35, s35, 7168
    s_cmp_ge_u32 s50, 168
    s_cbranch_scc1 L_gtx134
L_gt133:
    ds_read_b32 v100, v1 offset:20
    s_waitcnt lgkmcnt(0)
    v_readfirstlane_b32 s50, v100
    s_nop 0
    s_cmp_ge_u32 s50, 168
    s_cbranch_scc1 L_gtx134
    s_cmp_eq_u32 s28, 0
    s_cbranch_scc1 L_gtx134
    s_sub_u32 s28, s28, 1
    s_sleep 1
    s_branch L_gt133
L_gtx134:
    buffer_load_dwordx4 a[52:55], v15, s[4:7], s35 offen offset:0 sc1
    s_add_u32 s35, s35, 7168
    s_cmp_ge_u32 s50, 180
    s_cbranch_scc1 L_gtx136
L_gt135:
    ds_read_b32 v100, v1 offset:20
    s_waitcnt lgkmcnt(0)
    v_readfirstlane_b32 s50, v100
    s_nop 0
    s_cmp_ge_u32 s50, 180
    s_cbranch_scc1 L_gtx136
    s_cmp_eq_u32 s28, 0
    s_cbranch_scc1 L_gtx136
    s_sub_u32 s28, s28, 1
    s_sleep 1
    s_branch L_gt135
L_gtx136:
    buffer_load_dwordx4 a[56:59], v15, s[4:7], s35 offen offset:0 sc1
    s_add_u32 s35, s35, 7168
    s_cmp_ge_u32 s50, 192
    s_cbranch_scc1 L_gtx138
L_gt137:
    ds_read_b32 v100, v1 offset:20
    s_waitcnt lgkmcnt(0)
    v_readfirstlane_b32 s50, v100
    s_nop 0
    s_cmp_ge_u32 s50, 192
    s_cbranch_scc1 L_gtx138
    s_cmp_eq_u32 s28, 0
    s_cbranch_scc1 L_gtx138
    s_sub_u32 s28, s28, 1
    s_sleep 1
    s_branch L_gt137
L_gtx138:
    buffer_load_dwordx4 a[60:63], v15, s[4:7], s35 offen offset:0 sc1
    s_add_u32 s35, s35, 7168
    s_cmp_ge_u32 s50, 204
    s_cbranch_scc1 L_gtx140
L_gt139:
    ds_read_b32 v100, v1 offset:20
    s_waitcnt lgkmcnt(0)
    v_readfirstlane_b32 s50, v100
    s_nop 0
    s_cmp_ge_u32 s50, 204
    s_cbranch_scc1 L_gtx140
    s_cmp_eq_u32 s28, 0
    s_cbranch_scc1 L_gtx140
    s_sub_u32 s28, s28, 1
    s_sleep 1
    s_branch L_gt139
L_gtx140:
    buffer_load_dwordx4 a[64:67], v15, s[4:7], s35 offen offset:0 sc1
    s_add_u32 s35, s35, 7168
    s_cmp_ge_u32 s50, 216
    s_cbranch_scc1 L_gtx142
L_gt141:
    ds_read_b32 v100, v1 offset:20
    s_waitcnt lgkmcnt(0)
    v_readfirstlane_b32 s50, v100
    s_nop 0
    s_cmp_ge_u32 s50, 216
    s_cbranch_scc1 L_gtx142
    s_cmp_eq_u32 s28, 0
    s_cbranch_scc1 L_gtx142
    s_sub_u32 s28, s28, 1
    s_sleep 1
    s_branch L_gt141
L_gtx142:
    buffer_load_dwordx4 a[68:71], v15, s[4:7], s35 offen offset:0 sc1
    v_mov_b32 v18, 1
    s_mov_b64 exec, 1
    ds_add_u32 v1, v18 offset:44
    s_mov_b64 exec, -1
    s_waitcnt vmcnt(18)
    v_add_f32 v36, v36, v38
    v_add_f32 v37, v37, v39
    s_nop 0
    v_add_f32_dpp v36, v36, v36 quad_perm:[1,0,3,2] row_mask:0xf bank_mask:0xf
    v_add_f32_dpp v37, v37, v37 quad_perm:[1,0,3,2] row_mask:0xf bank_mask:0xf
    s_nop 0
    v_add_f32_dpp v36, v36, v36 quad_perm:[2,3,0,1] row_mask:0xf bank_mask:0xf
    v_add_f32_dpp v37, v37, v37 quad_perm:[2,3,0,1] row_mask:0xf bank_mask:0xf
    v_mul_f32 v36, 0x3ae38e39, v36
    v_mul_f32 v37, 0x3ae38e39, v37
    v_fma_f32 v37, -v36, v36, v37
    v_max_f32 v37, 0, v37
    v_cvt_pk_bf16_f32 v38, v36, v37
    v_lshlrev_b32 v36, 16, v38
    v_and_b32 v37, 0xffff0000, v38
    v_add_f32 v37, 0x3727c5ac, v37
    v_cvt_pk_bf16_f32 v38, v37, v37
    v_lshlrev_b32 v37, 16, v38
    v_sqrt_f32 v37, v37
    s_nop 0
    v_cvt_pk_bf16_f32 v38, v37, v37
    v_lshlrev_b32 v37, 16, v38
    v_rcp_f32 v37, v37
    v_xor_b32 v36, 0x80000000, v36
    v_mov_b32 v38, s33
    ds_write_b128 v17, v[36:39] offset:1280
    s_cmp_eq_u32 s36, 7
    s_cselect_b32 s40, 3840, 0
    s_add_u32 s33, s33, s40
    s_add_u32 s33, s33, 3840
    s_sub_u32 s40, s33, 19200
    s_cmp_ge_u32 s33, 157440
    s_cselect_b32 s33, s40, s33
    s_add_u32 s36, s36, 1
    v_add_f32 v40, v40, v42
    v_add_f32 v41, v41, v43
    s_nop 0
    v_add_f32_dpp v40, v40, v40 quad_perm:[1,0,3,2] row_mask:0xf bank_mask:0xf
    v_add_f32_dpp v41, v41, v41 quad_perm:[1,0,3,2] row_mask:0xf bank_mask:0xf
    s_nop 0
    v_add_f32_dpp v40, v40, v40 quad_perm:[2,3,0,1] row_mask:0xf bank_mask:0xf
    v_add_f32_dpp v41, v41, v41 quad_perm:[2,3,0,1] row_mask:0xf bank_mask:0xf
    v_mul_f32 v40, 0x3ae38e39, v40
    v_mul_f32 v41, 0x3ae38e39, v41
    v_fma_f32 v41, -v40, v40, v41
    v_max_f32 v41, 0, v41
    v_cvt_pk_bf16_f32 v42, v40, v41
    v_lshlrev_b32 v40, 16, v42
    v_and_b32 v41, 0xffff0000, v42
    v_add_f32 v41, 0x3727c5ac, v41
    v_cvt_pk_bf16_f32 v42, v41, v41
    v_lshlrev_b32 v41, 16, v42
    v_sqrt_f32 v41, v41
    s_nop 0
    v_cvt_pk_bf16_f32 v42, v41, v41
    v_lshlrev_b32 v41, 16, v42
    v_rcp_f32 v41, v41
    v_xor_b32 v40, 0x80000000, v40
    v_mov_b32 v42, s33
    ds_write_b128 v17, v[40:43] offset:1536
    s_cmp_eq_u32 s36, 7
    s_cselect_b32 s40, 3840, 0
    s_add_u32 s33, s33, s40
    s_add_u32 s33, s33, 3840
    s_sub_u32 s40, s33, 19200
    s_cmp_ge_u32 s33, 157440
    s_cselect_b32 s33, s40, s33
    s_add_u32 s36, s36, 1
    v_add_f32 v44, v44, v46
    v_add_f32 v45, v45, v47
    s_nop 0
    v_add_f32_dpp v44, v44, v44 quad_perm:[1,0,3,2] row_mask:0xf bank_mask:0xf
    v_add_f32_dpp v45, v45, v45 quad_perm:[1,0,3,2] row_mask:0xf bank_mask:0xf
    s_nop 0
    v_add_f32_dpp v44, v44, v44 quad_perm:[2,3,0,1] row_mask:0xf bank_mask:0xf
    v_add_f32_dpp v45, v45, v45 quad_perm:[2,3,0,1] row_mask:0xf bank_mask:0xf
    v_mul_f32 v44, 0x3ae38e39, v44
    v_mul_f32 v45, 0x3ae38e39, v45
    v_fma_f32 v45, -v44, v44, v45
    v_max_f32 v45, 0, v45
    v_cvt_pk_bf16_f32 v46, v44, v45
    v_lshlrev_b32 v44, 16, v46
    v_and_b32 v45, 0xffff0000, v46
    v_add_f32 v45, 0x3727c5ac, v45
    v_cvt_pk_bf16_f32 v46, v45, v45
    v_lshlrev_b32 v45, 16, v46
    v_sqrt_f32 v45, v45
    s_nop 0
    v_cvt_pk_bf16_f32 v46, v45, v45
    v_lshlrev_b32 v45, 16, v46
    v_rcp_f32 v45, v45
    v_xor_b32 v44, 0x80000000, v44
    v_mov_b32 v46, s33
    ds_write_b128 v17, v[44:47] offset:512
    s_cmp_eq_u32 s36, 7
    s_cselect_b32 s40, 3840, 0
    s_add_u32 s33, s33, s40
    s_add_u32 s33, s33, 3840
    s_sub_u32 s40, s33, 19200
    s_cmp_ge_u32 s33, 157440
    s_cselect_b32 s33, s40, s33
    s_add_u32 s36, s36, 1
    ds_write_b32 v1, v12 offset:68
    s_waitcnt lgkmcnt(0)
L_lw143:
    ds_read_b32 v18, v1 offset:72
    s_waitcnt lgkmcnt(0)
    v_readfirstlane_b32 s40, v18
    s_nop 0
    s_cmp_ge_u32 s40, 3
    s_cbranch_scc1 L_lwx144
    s_cmp_eq_u32 s28, 0
    s_cbranch_scc1 L_lwx144
    s_sub_u32 s28, s28, 1
    s_branch L_lw143
L_lwx144:
    ds_read_b128 v[72:75], v6 offset:0
    ds_read_b128 v[76:79], v6 offset:18432
    ds_read_b128 v[80:83], v6 offset:36864
    ds_read_b128 v[84:87], v7 offset:0
    ds_read_b128 v[88:91], v7 offset:18432
    ds_read_b128 v[92:95], v7 offset:36864
    s_waitcnt vmcnt(17)
    v_mfma_f32_16x16x32_bf16 v[24:27], a[0:3], v[96:99], 0
    s_waitcnt lgkmcnt(5)
    v_mfma_f32_16x16x32_bf16 v[48:51], a[0:3], v[72:75], 0
    s_waitcnt lgkmcnt(4)
    v_mfma_f32_16x16x32_bf16 v[56:59], a[0:3], v[76:79], 0
    s_waitcnt lgkmcnt(3)
    v_mfma_f32_16x16x32_bf16 v[32:35], a[0:3], v[80:83], 0
    ds_read_b128 v[72:75], v6 offset:1024
    ds_read_b128 v[76:79], v6 offset:19456
    ds_read_b128 v[80:83], v6 offset:37888
    s_waitcnt vmcnt(16)
    v_mfma_f32_16x16x32_bf16 v[24:27], a[4:7], v[96:99], v[24:27]
    s_waitcnt lgkmcnt(5)
    v_mfma_f32_16x16x32_bf16 v[48:51], a[4:7], v[84:87], v[48:51]
    s_waitcnt lgkmcnt(4)
    v_mfma_f32_16x16x32_bf16 v[56:59], a[4:7], v[88:91], v[56:59]
    s_waitcnt lgkmcnt(3)
    v_mfma_f32_16x16x32_bf16 v[32:35], a[4:7], v[92:95], v[32:35]
    ds_read_b128 v[84:87], v7 offset:1024
    ds_read_b128 v[88:91], v7 offset:19456
    ds_read_b128 v[92:95], v7 offset:37888
    s_waitcnt vmcnt(15)
    v_mfma_f32_16x16x32_bf16 v[24:27], a[8:11], v[96:99], v[24:27]
    s_waitcnt lgkmcnt(5)
    v_mfma_f32_16x16x32_bf16 v[48:51], a[8:11], v[72:75], v[48:51]
    s_waitcnt lgkmcnt(4)
    v_mfma_f32_16x16x32_bf16 v[56:59], a[8:11], v[76:79], v[56:59]
    s_waitcnt lgkmcnt(3)
    v_mfma_f32_16x16x32_bf16 v[32:35], a[8:11], v[80:83], v[32:35]
    ds_read_b128 v[72:75], v6 offset:2048
    ds_read_b128 v[76:79], v6 offset:20480
    ds_read_b128 v[80:83], v6 offset:38912
    s_waitcnt vmcnt(14)
    v_mfma_f32_16x16x32_bf16 v[24:27], a[12:15], v[96:99], v[24:27]
    s_waitcnt lgkmcnt(5)
    v_mfma_f32_16x16x32_bf16 v[48:51], a[12:15], v[84:87], v[48:51]
    s_waitcnt lgkmcnt(4)
    v_mfma_f32_16x16x32_bf16 v[56:59], a[12:15], v[88:91], v[56:59]
    s_waitcnt lgkmcnt(3)
    v_mfma_f32_16x16x32_bf16 v[32:35], a[12:15], v[92:95], v[32:35]
    ds_read_b128 v[84:87], v7 offset:2048
    ds_read_b128 v[88:91], v7 offset:20480
    ds_read_b128 v[92:95], v7 offset:38912
    s_waitcnt vmcnt(13)
    v_mfma_f32_16x16x32_bf16 v[24:27], a[16:19], v[96:99], v[24:27]
    s_waitcnt lgkmcnt(5)
    v_mfma_f32_16x16x32_bf16 v[48:51], a[16:19], v[72:75], v[48:51]
    s_waitcnt lgkmcnt(4)
    v_mfma_f32_16x16x32_bf16 v[56:59], a[16:19], v[76:79], v[56:59]
    s_waitcnt lgkmcnt(3)
    v_mfma_f32_16x16x32_bf16 v[32:35], a[16:19], v[80:83], v[32:35]
    ds_read_b128 v[72:75], v6 offset:3072
    ds_read_b128 v[76:79], v6 offset:21504
    ds_read_b128 v[80:83], v6 offset:39936
    s_waitcnt vmcnt(12)
    v_mfma_f32_16x16x32_bf16 v[24:27], a[20:23], v[96:99], v[24:27]
    s_waitcnt lgkmcnt(5)
    v_mfma_f32_16x16x32_bf16 v[48:51], a[20:23], v[84:87], v[48:51]
    s_waitcnt lgkmcnt(4)
    v_mfma_f32_16x16x32_bf16 v[56:59], a[20:23], v[88:91], v[56:59]
    s_waitcnt lgkmcnt(3)
    v_mfma_f32_16x16x32_bf16 v[32:35], a[20:23], v[92:95], v[32:35]
    ds_read_b128 v[84:87], v7 offset:3072
    ds_read_b128 v[88:91], v7 offset:21504
    ds_read_b128 v[92:95], v7 offset:39936
    s_waitcnt vmcnt(11)
    v_mfma_f32_16x16x32_bf16 v[24:27], a[24:27], v[96:99], v[24:27]
    s_waitcnt lgkmcnt(5)
    v_mfma_f32_16x16x32_bf16 v[48:51], a[24:27], v[72:75], v[48:51]
    s_waitcnt lgkmcnt(4)
    v_mfma_f32_16x16x32_bf16 v[56:59], a[24:27], v[76:79], v[56:59]
    s_waitcnt lgkmcnt(3)
    v_mfma_f32_16x16x32_bf16 v[32:35], a[24:27], v[80:83], v[32:35]
    ds_read_b128 v[72:75], v6 offset:4096
    ds_read_b128 v[76:79], v6 offset:22528
    ds_read_b128 v[80:83], v6 offset:40960
    s_waitcnt vmcnt(10)
    v_mfma_f32_16x16x32_bf16 v[24:27], a[28:31], v[96:99], v[24:27]
    s_waitcnt lgkmcnt(5)
    v_mfma_f32_16x16x32_bf16 v[48:51], a[28:31], v[84:87], v[48:51]
    s_waitcnt lgkmcnt(4)
    v_mfma_f32_16x16x32_bf16 v[56:59], a[28:31], v[88:91], v[56:59]
    s_waitcnt lgkmcnt(3)
    v_mfma_f32_16x16x32_bf16 v[32:35], a[28:31], v[92:95], v[32:35]
    ds_read_b128 v[84:87], v7 offset:4096
    ds_read_b128 v[88:91], v7 offset:22528
    ds_read_b128 v[92:95], v7 offset:40960
    s_waitcnt vmcnt(9)
    v_mfma_f32_16x16x32_bf16 v[24:27], a[32:35], v[96:99], v[24:27]
    s_waitcnt lgkmcnt(5)
    v_mfma_f32_16x16x32_bf16 v[48:51], a[32:35], v[72:75], v[48:51]
    s_waitcnt lgkmcnt(4)
    v_mfma_f32_16x16x32_bf16 v[56:59], a[32:35], v[76:79], v[56:59]
    s_waitcnt lgkmcnt(3)
    v_mfma_f32_16x16x32_bf16 v[32:35], a[32:35], v[80:83], v[32:35]
    ds_read_b128 v[72:75], v6 offset:5120
    ds_read_b128 v[76:79], v6 offset:23552
    ds_read_b128 v[80:83], v6 offset:41984
    s_waitcnt vmcnt(8)
    v_mfma_f32_16x16x32_bf16 v[24:27], a[36:39], v[96:99], v[24:27]
    s_waitcnt lgkmcnt(5)
    v_mfma_f32_16x16x32_bf16 v[48:51], a[36:39], v[84:87], v[48:51]
    s_waitcnt lgkmcnt(4)
    v_mfma_f32_16x16x32_bf16 v[56:59], a[36:39], v[88:91], v[56:59]
    s_waitcnt lgkmcnt(3)
    v_mfma_f32_16x16x32_bf16 v[32:35], a[36:39], v[92:95], v[32:35]
    ds_read_b128 v[84:87], v7 offset:5120
    ds_read_b128 v[88:91], v7 offset:23552
    ds_read_b128 v[92:95], v7 offset:41984
    s_waitcnt vmcnt(7)
    v_mfma_f32_16x16x32_bf16 v[24:27], a[40:43], v[96:99], v[24:27]
    s_waitcnt lgkmcnt(5)
    v_mfma_f32_16x16x32_bf16 v[48:51], a[40:43], v[72:75], v[48:51]
    s_waitcnt lgkmcnt(4)
    v_mfma_f32_16x16x32_bf16 v[56:59], a[40:43], v[76:79], v[56:59]
    s_waitcnt lgkmcnt(3)
    v_mfma_f32_16x16x32_bf16 v[32:35], a[40:43], v[80:83], v[32:35]
    ds_read_b128 v[72:75], v6 offset:6144
    ds_read_b128 v[76:79], v6 offset:24576
    ds_read_b128 v[80:83], v6 offset:43008
    s_waitcnt vmcnt(6)
    v_mfma_f32_16x16x32_bf16 v[24:27], a[44:47], v[96:99], v[24:27]
    s_waitcnt lgkmcnt(5)
    v_mfma_f32_16x16x32_bf16 v[48:51], a[44:47], v[84:87], v[48:51]
    s_waitcnt lgkmcnt(4)
    v_mfma_f32_16x16x32_bf16 v[56:59], a[44:47], v[88:91], v[56:59]
    s_waitcnt lgkmcnt(3)
    v_mfma_f32_16x16x32_bf16 v[32:35], a[44:47], v[92:95], v[32:35]
    ds_read_b128 v[84:87], v7 offset:6144
    ds_read_b128 v[88:91], v7 offset:24576
    ds_read_b128 v[92:95], v7 offset:43008
    s_waitcnt vmcnt(5)
    v_mfma_f32_16x16x32_bf16 v[24:27], a[48:51], v[96:99], v[24:27]
    s_waitcnt lgkmcnt(5)
    v_mfma_f32_16x16x32_bf16 v[48:51], a[48:51], v[72:75], v[48:51]
    s_waitcnt lgkmcnt(4)
    v_mfma_f32_16x16x32_bf16 v[56:59], a[48:51], v[76:79], v[56:59]
    s_waitcnt lgkmcnt(3)
    v_mfma_f32_16x16x32_bf16 v[32:35], a[48:51], v[80:83], v[32:35]
    ds_read_b128 v[72:75], v6 offset:7168
    ds_read_b128 v[76:79], v6 offset:25600
    ds_read_b128 v[80:83], v6 offset:44032
    s_waitcnt vmcnt(4)
    v_mfma_f32_16x16x32_bf16 v[24:27], a[52:55], v[96:99], v[24:27]
    s_waitcnt lgkmcnt(5)
    v_mfma_f32_16x16x32_bf16 v[48:51], a[52:55], v[84:87], v[48:51]
    s_waitcnt lgkmcnt(4)
    v_mfma_f32_16x16x32_bf16 v[56:59], a[52:55], v[88:91], v[56:59]
    s_waitcnt lgkmcnt(3)
    v_mfma_f32_16x16x32_bf16 v[32:35], a[52:55], v[92:95], v[32:35]
    ds_read_b128 v[84:87], v7 offset:7168
    ds_read_b128 v[88:91], v7 offset:25600
    ds_read_b128 v[92:95], v7 offset:44032
    s_waitcnt vmcnt(3)
    v_mfma_f32_16x16x32_bf16 v[24:27], a[56:59], v[96:99], v[24:27]
    s_waitcnt lgkmcnt(5)
    v_mfma_f32_16x16x32_bf16 v[48:51], a[56:59], v[72:75], v[48:51]
    s_waitcnt lgkmcnt(4)
    v_mfma_f32_16x16x32_bf16 v[56:59], a[56:59], v[76:79], v[56:59]
    s_waitcnt lgkmcnt(3)
    v_mfma_f32_16x16x32_bf16 v[32:35], a[56:59], v[80:83], v[32:35]
    ds_read_b128 v[72:75], v6 offset:8192
    ds_read_b128 v[76:79], v6 offset:26624
    ds_read_b128 v[80:83], v6 offset:45056
    s_waitcnt vmcnt(2)
    v_mfma_f32_16x16x32_bf16 v[24:27], a[60:63], v[96:99], v[24:27]
    s_waitcnt lgkmcnt(5)
    v_mfma_f32_16x16x32_bf16 v[48:51], a[60:63], v[84:87], v[48:51]
    s_waitcnt lgkmcnt(4)
    v_mfma_f32_16x16x32_bf16 v[56:59], a[60:63], v[88:91], v[56:59]
    s_waitcnt lgkmcnt(3)
    v_mfma_f32_16x16x32_bf16 v[32:35], a[60:63], v[92:95], v[32:35]
    ds_read_b128 v[84:87], v7 offset:8192
    ds_read_b128 v[88:91], v7 offset:26624
    ds_read_b128 v[92:95], v7 offset:45056
    s_waitcnt vmcnt(1)
    v_mfma_f32_16x16x32_bf16 v[24:27], a[64:67], v[96:99], v[24:27]
    s_waitcnt lgkmcnt(5)
    v_mfma_f32_16x16x32_bf16 v[48:51], a[64:67], v[72:75], v[48:51]
    s_waitcnt lgkmcnt(4)
    v_mfma_f32_16x16x32_bf16 v[56:59], a[64:67], v[76:79], v[56:59]
    s_waitcnt lgkmcnt(3)
    v_mfma_f32_16x16x32_bf16 v[32:35], a[64:67], v[80:83], v[32:35]
    s_waitcnt vmcnt(0)
    v_mfma_f32_16x16x32_bf16 v[24:27], a[68:71], v[96:99], v[24:27]
    s_waitcnt lgkmcnt(2)
    v_mfma_f32_16x16x32_bf16 v[48:51], a[68:71], v[84:87], v[48:51]
    s_waitcnt lgkmcnt(1)
    v_mfma_f32_16x16x32_bf16 v[56:59], a[68:71], v[88:91], v[56:59]
    s_waitcnt lgkmcnt(0)
    v_mfma_f32_16x16x32_bf16 v[32:35], a[68:71], v[92:95], v[32:35]
    ds_write_b8 v11, v12 offset:132
    ds_write_b8 v11, v12 offset:136
    ds_write_b8 v11, v12 offset:140
L_tok145:
    ds_read_b64 v[18:19], v1
    s_waitcnt lgkmcnt(0)
    v_readfirstlane_b32 s40, v18
    v_readfirstlane_b32 s41, v19
    s_cmp_eq_u32 s40, 2
    s_cbranch_scc1 L5_fallback
    s_cmp_eq_u32 s40, 1
    s_cbranch_scc1 L_tokx146
    s_cmp_eq_u32 s28, 0
    s_cbranch_scc1 L_tokx146
    s_sub_u32 s28, s28, 1
    s_sleep 1
    s_branch L_tok145
L_tokx146:
    ds_read_b128 v[20:23], v13 offset:1280
    s_waitcnt lgkmcnt(0)
    v_fma_f32 v64, v24, v20, v48
    v_fma_f32 v65, v25, v20, v49
    v_fma_f32 v66, v26, v20, v50
    v_fma_f32 v67, v27, v20, v51
    v_mul_f32 v64, v64, v21
    v_mul_f32 v65, v65, v21
    v_mul_f32 v66, v66, v21
    v_mul_f32 v67, v67, v21
    v_cvt_pk_bf16_f32 v64, v64, v65
    v_cvt_pk_bf16_f32 v65, v66, v67
    v_add_u32 v16, v14, v22
    ds_write_b64 v16, v[64:65]
    ds_write_b8 v11, v12 offset:212
    ds_read_b128 v[20:23], v13 offset:1536
    s_waitcnt lgkmcnt(0)
    v_fma_f32 v64, v24, v20, v56
    v_fma_f32 v65, v25, v20, v57
    v_fma_f32 v66, v26, v20, v58
    v_fma_f32 v67, v27, v20, v59
    v_mul_f32 v64, v64, v21
    v_mul_f32 v65, v65, v21
    v_mul_f32 v66, v66, v21
    v_mul_f32 v67, v67, v21
    v_cvt_pk_bf16_f32 v64, v64, v65
    v_cvt_pk_bf16_f32 v65, v66, v67
    v_add_u32 v16, v14, v22
    ds_write_b64 v16, v[64:65]
    ds_write_b8 v11, v12 offset:216
    s_mul_i32 s40, s23, 147456
    s_add_u32 s8, s64, s40
    s_addc_u32 s9, s65, 0
    s_sub_u32 s8, s8, 2688
    s_subb_u32 s9, s9, 0
    s_mov_b32 s10, 151552
    s_add_u32 s40, s40, 8385920
    s_add_u32 s12, s86, s40
    s_addc_u32 s13, s87, 0
    s_sub_u32 s15, s39, 3072
    v_add_u32 v102, 73728, v102
    v_add_u32 v103, 73728, v103
    v_mul_u32_u24 v87, 86, v2
    v_lshrrev_b32 v87, 8, v87
    v_mul_u32_u24 v87, 3, v87
    v_sub_u32 v87, v2, v87
    v_mul_u32_u24 v87, 18432, v87
    v_add_u32 v87, 82944, v87
    v_lshrrev_b32 v84, 3, v2
    v_add_u32 v84, v2, v84
    v_mul_u32_u24 v86, 205, v84
    v_lshrrev_b32 v86, 10, v86
    v_mul_u32_u24 v86, 5, v86
    v_sub_u32 v86, v84, v86
    v_mul_u32_u24 v86, 3840, v86
    v_add_u32 v86, 138240, v86
    v_lshl_add_u32 v84, v2, 2, v1
    ds_read_b128 v[20:23], v13 offset:512
    s_waitcnt lgkmcnt(0)
    v_fma_f32 v64, v24, v20, v32
    v_fma_f32 v65, v25, v20, v33
    v_fma_f32 v66, v26, v20, v34
    v_fma_f32 v67, v27, v20, v35
    v_mul_f32 v64, v64, v21
    v_mul_f32 v65, v65, v21
    v_mul_f32 v66, v66, v21
    v_mul_f32 v67, v67, v21
    v_cvt_pk_bf16_f32 v64, v64, v65
    v_cvt_pk_bf16_f32 v65, v66, v67
    v_add_u32 v16, v14, v22
    ds_write_b64 v16, v[64:65]
    ds_write_b8 v11, v12 offset:220
    s_mov_b32 s36, 3
    s_mov_b32 s32, 3
    s_mov_b32 s37, 3
    s_mov_b32 s38, 32
    s_mov_b32 s91, 0
    s_mov_b64 s[44:45], 0
    s_mov_b64 s[18:19], -1
    v_mov_b32 v8, v1
    v_mov_b32 v108, 0
    s_branch L5_m
L5_m_fix:
    s_mov_b64 s[8:9], s[12:13]
    s_mov_b64 s[18:19], 0
    s_mov_b32 s38, 56
    s_add_u32 s15, s15, 24576
    v_add_u32 v102, 147456, v102
    v_add_u32 v103, 147456, v103
    s_cmp_eq_u32 s36, 16
    s_cselect_b32 s51, -1, s51
    s_branch L5_m2
L5_m:
    ds_read_b32 v100, v8 offset:144
    s_waitcnt lgkmcnt(0)
L5_m2:
    v_readfirstlane_b32 s40, v100
    s_or_b64 s[42:43], s[44:45], s[18:19]
    s_lshr_b64 s[42:43], s[42:43], s38
    s_andn2_b32 s42, 0xff, s42
    s_xor_b32 s40, s40, s51
    s_or_b32 s40, s40, s42
    s_cbranch_scc1 L5_m_nf
    s_cmp_lt_u32 s32, s37
    s_cbranch_scc0 L5_m_f
    v_readlane_b32 s34, v87, s36
    v_readlane_b32 s46, v87, s32
    s_waitcnt vmcnt(18)
    v_add_f32 v80, v104, v106
    v_add_f32 v81, v105, v107
    buffer_load_dword v108, v109, s[4:7], s52 offen sc1
    s_mov_b32 m0, s34
    buffer_load_dwordx4 v[104:107], v3, s[4:7], s15 offen sc1
    v_add_u32 v6, s46, v4
    v_add_u32 v7, s46, v5
    buffer_load_dwordx4 v102, s[8:11], s54 offen offset:0 sc1 lds
    ds_read_b128 a[72:75], v6 offset:0
    ds_read_b128 a[76:79], v7 offset:0
    ds_read_b128 a[80:83], v6 offset:1024
    v_readlane_b32 s33, v86, s37
    v_add_f32_dpp v80, v80, v80 quad_perm:[1,0,3,2] row_mask:0xf bank_mask:0xf
    v_add_f32_dpp v81, v81, v81 quad_perm:[1,0,3,2] row_mask:0xf bank_mask:0xf
    buffer_load_dwordx4 v102, s[8:11], s55 offen offset:1024 sc1 lds
    ds_read_b128 a[84:87], v7 offset:1024
    ds_read_b128 a[88:91], v6 offset:2048
    ds_read_b128 a[92:95], v7 offset:2048
    s_and_b32 s48, s37, 3
    s_cmp_lt_u32 s37, s36
    s_cselect_b32 s90, 1, 0
    s_cselect_b32 s48, s48, 4
    s_cselect_b32 s47, s37, 17
    v_add_f32_dpp v80, v80, v80 quad_perm:[2,3,0,1] row_mask:0xf bank_mask:0xf
    buffer_load_dwordx4 v102, s[8:11], s56 offen offset:2048 sc1 lds
    ds_read_b128 a[96:99], v6 offset:3072
    ds_read_b128 a[100:103], v7 offset:3072
    ds_read_b128 a[104:107], v6 offset:4096
    v_add_f32_dpp v81, v81, v81 quad_perm:[2,3,0,1] row_mask:0xf bank_mask:0xf
    s_lshl_b32 s48, s48, 8
    s_lshl_b64 s[92:93], 1, s47
    buffer_load_dwordx4 v102, s[8:11], s57 offen offset:3072 sc1 lds
    s_add_u32 m0, s34, 4096
    ds_read_b128 a[108:111], v7 offset:4096
    ds_read_b128 a[112:115], v6 offset:5120
    ds_read_b128 a[116:119], v7 offset:5120
    v_add_u32 v9, s48, v17
    v_mul_f32 v80, 0x3ae38e39, v80
    v_mul_f32 v81, 0x3ae38e39, v81
    s_waitcnt lgkmcnt(9)
    v_mfma_f32_16x16x32_bf16 v[72:75], a[0:3], a[72:75], 0
    buffer_load_dwordx4 v102, s[8:11], s58 offen offset:0 sc1 lds
    ds_read_b128 a[120:123], v6 offset:6144
    ds_read_b128 a[124:127], v7 offset:6144
    v_fma_f32 v81, -v80, v80, v81
    v_max_f32 v81, 0, v81
    v_cvt_pk_bf16_f32 v82, v80, v81
    v_mfma_f32_16x16x32_bf16 v[72:75], a[4:7], a[76:79], v[72:75]
    buffer_load_dwordx4 v102, s[8:11], s59 offen offset:1024 sc1 lds
    ds_read_b128 a[128:131], v6 offset:7168
    ds_read_b128 a[132:135], v7 offset:7168
    v_lshlrev_b32 v80, 16, v82
    v_and_b32 v81, 0xffff0000, v82
    v_add_f32 v81, 0x3727c5ac, v81
    v_mfma_f32_16x16x32_bf16 v[72:75], a[8:11], a[80:83], v[72:75]
    buffer_load_dwordx4 v102, s[8:11], s60 offen offset:2048 sc1 lds
    ds_read_b128 a[136:139], v6 offset:8192
    ds_read_b128 a[140:143], v7 offset:8192
    v_cvt_pk_bf16_f32 v82, v81, v81
    v_lshlrev_b32 v81, 16, v82
    v_sqrt_f32 v81, v81
    s_waitcnt lgkmcnt(12)
    v_mfma_f32_16x16x32_bf16 v[72:75], a[12:15], a[84:87], v[72:75]
    buffer_load_dwordx4 v102, s[8:11], s61 offen offset:3072 sc1 lds
    s_add_u32 m0, s34, 8192
    ds_write_b8 v11, v12 offset:144
    s_and_b32 s49, s32, 3
    s_lshl_b32 s49, s49, 8
    v_add_u32 v19, s49, v13
    ds_read_b128 v[20:23], v19
    v_cvt_pk_bf16_f32 v82, v81, v81
    v_lshlrev_b32 v81, 16, v82
    v_rcp_f32 v81, v81
    v_mfma_f32_16x16x32_bf16 v[72:75], a[16:19], a[88:91], v[72:75]
    buffer_load_dwordx4 v102, s[8:11], s62 offen offset:0 sc1 lds
    s_add_u32 m0, s34, 9216
    ds_read_b32 v18, v10 offset:304
    v_xor_b32 v80, 0x80000000, v80
    v_mov_b32 v82, s33
    ds_write_b128 v9, v[80:83]
    v_mfma_f32_16x16x32_bf16 v[72:75], a[20:23], a[92:95], v[72:75]
    buffer_load_dwordx4 v103, s[8:11], s54 offen offset:0 sc1 lds
    s_waitcnt vmcnt(12)
    s_mov_b64 exec, s[92:93]
    ds_write_b32 v84, v87 offset:64
    s_mov_b64 exec, -1
    s_add_u32 s37, s37, s90
    s_waitcnt lgkmcnt(14)
    v_mfma_f32_16x16x32_bf16 v[72:75], a[24:27], a[96:99], v[72:75]
    v_mfma_f32_16x16x32_bf16 v[72:75], a[28:31], a[100:103], v[72:75]
    buffer_load_dwordx4 v103, s[8:11], s55 offen offset:1024 sc1 lds
    v_mfma_f32_16x16x32_bf16 v[72:75], a[32:35], a[104:107], v[72:75]
    s_waitcnt lgkmcnt(11)
    v_mfma_f32_16x16x32_bf16 v[72:75], a[36:39], a[108:111], v[72:75]
    buffer_load_dwordx4 v103, s[8:11], s56 offen offset:2048 sc1 lds
    v_mfma_f32_16x16x32_bf16 v[72:75], a[40:43], a[112:115], v[72:75]
    v_mfma_f32_16x16x32_bf16 v[72:75], a[44:47], a[116:119], v[72:75]
    buffer_load_dwordx4 v103, s[8:11], s57 offen offset:3072 sc1 lds
    s_add_u32 m0, s34, 13312
    s_waitcnt lgkmcnt(8)
    v_mfma_f32_16x16x32_bf16 v[72:75], a[48:51], a[120:123], v[72:75]
    v_mfma_f32_16x16x32_bf16 v[72:75], a[52:55], a[124:127], v[72:75]
    v_subrev_u32 v102, 18432, v102
    s_sub_u32 s15, s15, 1024
    s_sub_u32 s38, s38, 8
    s_add_u32 s36, s36, 1
    buffer_load_dwordx4 v103, s[8:11], s58 offen offset:0 sc1 lds
    v_mfma_f32_16x16x32_bf16 v[72:75], a[56:59], a[128:131], v[72:75]
    s_waitcnt lgkmcnt(5)
    v_mfma_f32_16x16x32_bf16 v[72:75], a[60:63], a[132:135], v[72:75]
    buffer_load_dwordx4 v103, s[8:11], s59 offen offset:1024 sc1 lds
    v_mfma_f32_16x16x32_bf16 v[72:75], a[64:67], a[136:139], v[72:75]
    v_mfma_f32_16x16x32_bf16 v[72:75], a[68:71], a[140:143], v[72:75]
    buffer_load_dwordx4 v103, s[8:11], s60 offen offset:2048 sc1 lds
    s_waitcnt lgkmcnt(2)
    v_readfirstlane_b32 s40, v18
    s_nop 0
    s_cmp_ge_u32 s40, 2
    s_cbranch_scc1 L_mfr147
L_fr148:
    ds_read_b32 v18, v10 offset:304
    s_waitcnt lgkmcnt(0)
    v_readfirstlane_b32 s40, v18
    s_nop 0
    s_cmp_ge_u32 s40, 2
    s_cbranch_scc1 L_frx149
    s_cmp_eq_u32 s28, 0
    s_cbranch_scc1 L_frx149
    s_sub_u32 s28, s28, 1
    s_branch L_fr148
L_frx149:
L_mfr147:
    s_nop 2
    buffer_load_dwordx4 v103, s[8:11], s61 offen offset:3072 sc1 lds
    s_add_u32 m0, s34, 17408
    ds_read_b32 v100, v8 offset:148
    v_fma_f32 v64, v24, v20, v72
    v_fma_f32 v65, v25, v20, v73
    v_fma_f32 v66, v26, v20, v74
    v_fma_f32 v67, v27, v20, v75
    v_mul_f32 v64, v64, v21
    buffer_load_dwordx4 v103, s[8:11], s62 offen offset:0 sc1 lds
    v_mul_f32 v65, v65, v21
    v_mul_f32 v66, v66, v21
    v_mul_f32 v67, v67, v21
    v_cvt_pk_bf16_f32 v64, v64, v65
    v_cvt_pk_bf16_f32 v65, v66, v67
    v_subrev_u32 v103, 18432, v103
    v_add_u32 v8, 4, v8
    v_add_u32 v16, v14, v22
    ds_write_b64 v16, v[64:65]
    ds_write_b8 v11, v12 offset:224
    v_add_u32 v10, 4, v10
    v_add_u32 v11, 4, v11
    s_add_u32 s32, s32, 1
    s_and_b32 s40, s36, 7
    s_waitcnt vmcnt(19) lgkmcnt(2)
    v_cmp_eq_u32 s[44:45], s94, v108
    s_cbranch_scc0 L5_m_fix
    s_branch L5_m2
L5_m_f:
    v_readlane_b32 s34, v87, s36
    s_waitcnt vmcnt(18)
    v_add_f32 v80, v104, v106
    v_add_f32 v81, v105, v107
    buffer_load_dword v108, v109, s[4:7], s52 offen sc1
    s_mov_b32 m0, s34
    buffer_load_dwordx4 v[104:107], v3, s[4:7], s15 offen sc1
    buffer_load_dwordx4 v102, s[8:11], s54 offen offset:0 sc1 lds
    v_readlane_b32 s33, v86, s37
    v_add_f32_dpp v80, v80, v80 quad_perm:[1,0,3,2] row_mask:0xf bank_mask:0xf
    v_add_f32_dpp v81, v81, v81 quad_perm:[1,0,3,2] row_mask:0xf bank_mask:0xf
    buffer_load_dwordx4 v102, s[8:11], s55 offen offset:1024 sc1 lds
    s_and_b32 s48, s37, 3
    s_cmp_lt_u32 s37, s36
    s_cselect_b32 s90, 1, 0
    s_cselect_b32 s48, s48, 4
    s_cselect_b32 s47, s37, 17
    v_add_f32_dpp v80, v80, v80 quad_perm:[2,3,0,1] row_mask:0xf bank_mask:0xf
    buffer_load_dwordx4 v102, s[8:11], s56 offen offset:2048 sc1 lds
    v_add_f32_dpp v81, v81, v81 quad_perm:[2,3,0,1] row_mask:0xf bank_mask:0xf
    s_lshl_b32 s48, s48, 8
    s_lshl_b64 s[92:93], 1, s47
    buffer_load_dwordx4 v102, s[8:11], s57 offen offset:3072 sc1 lds
    s_add_u32 m0, s34, 4096
    v_add_u32 v9, s48, v17
    v_mul_f32 v80, 0x3ae38e39, v80
    v_mul_f32 v81, 0x3ae38e39, v81
    buffer_load_dwordx4 v102, s[8:11], s58 offen offset:0 sc1 lds
    v_fma_f32 v81, -v80, v80, v81
    v_max_f32 v81, 0, v81
    v_cvt_pk_bf16_f32 v82, v80, v81
    buffer_load_dwordx4 v102, s[8:11], s59 offen offset:1024 sc1 lds
    v_lshlrev_b32 v80, 16, v82
    v_and_b32 v81, 0xffff0000, v82
    v_add_f32 v81, 0x3727c5ac, v81
    buffer_load_dwordx4 v102, s[8:11], s60 offen offset:2048 sc1 lds
    v_cvt_pk_bf16_f32 v82, v81, v81
    v_lshlrev_b32 v81, 16, v82
    v_sqrt_f32 v81, v81
    buffer_load_dwordx4 v102, s[8:11], s61 offen offset:3072 sc1 lds
    s_add_u32 m0, s34, 8192
    v_cvt_pk_bf16_f32 v82, v81, v81
    v_lshlrev_b32 v81, 16, v82
    v_rcp_f32 v81, v81
    buffer_load_dwordx4 v102, s[8:11], s62 offen offset:0 sc1 lds
    s_add_u32 m0, s34, 9216
    v_xor_b32 v80, 0x80000000, v80
    v_mov_b32 v82, s33
    ds_write_b128 v9, v[80:83]
    buffer_load_dwordx4 v103, s[8:11], s54 offen offset:0 sc1 lds
    s_waitcnt vmcnt(12)
    s_mov_b64 exec, s[92:93]
    ds_write_b32 v84, v87 offset:64
    s_mov_b64 exec, -1
    s_add_u32 s37, s37, s90
    buffer_load_dwordx4 v103, s[8:11], s55 offen offset:1024 sc1 lds
    buffer_load_dwordx4 v103, s[8:11], s56 offen offset:2048 sc1 lds
    buffer_load_dwordx4 v103, s[8:11], s57 offen offset:3072 sc1 lds
    s_add_u32 m0, s34, 13312
    v_subrev_u32 v102, 18432, v102
    s_sub_u32 s15, s15, 1024
    s_sub_u32 s38, s38, 8
    s_add_u32 s36, s36, 1
    buffer_load_dwordx4 v103, s[8:11], s58 offen offset:0 sc1 lds
    buffer_load_dwordx4 v103, s[8:11], s59 offen offset:1024 sc1 lds
    buffer_load_dwordx4 v103, s[8:11], s60 offen offset:2048 sc1 lds
    buffer_load_dwordx4 v103, s[8:11], s61 offen offset:3072 sc1 lds
    s_add_u32 m0, s34, 17408
    ds_read_b32 v100, v8 offset:148
    buffer_load_dwordx4 v103, s[8:11], s62 offen offset:0 sc1 lds
    v_subrev_u32 v103, 18432, v103
    v_add_u32 v8, 4, v8
    s_and_b32 s40, s36, 7
    s_waitcnt vmcnt(19) lgkmcnt(0)
    v_cmp_eq_u32 s[44:45], s94, v108
    s_cbranch_scc0 L5_m_fix
    s_branch L5_m2
L5_m_nf:
    s_cmp_lt_u32 s32, s37
    s_cbranch_scc0 L5_m_idle
    v_readlane_b32 s46, v87, s32
    s_waitcnt vmcnt(18)
    v_add_f32 v80, v104, v106
    v_add_f32 v81, v105, v107
    buffer_load_dword v108, v109, s[4:7], s52 offen sc1
    v_add_u32 v6, s46, v4
    v_add_u32 v7, s46, v5
    ds_read_b128 a[72:75], v6 offset:0
    ds_read_b128 a[76:79], v7 offset:0
    ds_read_b128 a[80:83], v6 offset:1024
    v_readlane_b32 s33, v86, s37
    v_add_f32_dpp v80, v80, v80 quad_perm:[1,0,3,2] row_mask:0xf bank_mask:0xf
    v_add_f32_dpp v81, v81, v81 quad_perm:[1,0,3,2] row_mask:0xf bank_mask:0xf
    ds_read_b128 a[84:87], v7 offset:1024
    ds_read_b128 a[88:91], v6 offset:2048
    ds_read_b128 a[92:95], v7 offset:2048
    s_and_b32 s48, s37, 3
    s_cmp_lt_u32 s37, s36
    s_cselect_b32 s90, 1, 0
    s_cselect_b32 s48, s48, 4
    s_cselect_b32 s47, s37, 17
    v_add_f32_dpp v80, v80, v80 quad_perm:[2,3,0,1] row_mask:0xf bank_mask:0xf
    ds_read_b128 a[96:99], v6 offset:3072
    ds_read_b128 a[100:103], v7 offset:3072
    ds_read_b128 a[104:107], v6 offset:4096
    v_add_f32_dpp v81, v81, v81 quad_perm:[2,3,0,1] row_mask:0xf bank_mask:0xf
    s_lshl_b32 s48, s48, 8
    s_lshl_b64 s[92:93], 1, s47
    ds_read_b128 a[108:111], v7 offset:4096
    ds_read_b128 a[112:115], v6 offset:5120
    ds_read_b128 a[116:119], v7 offset:5120
    v_add_u32 v9, s48, v17
    v_mul_f32 v80, 0x3ae38e39, v80
    v_mul_f32 v81, 0x3ae38e39, v81
    s_waitcnt lgkmcnt(9)
    v_mfma_f32_16x16x32_bf16 v[72:75], a[0:3], a[72:75], 0
    ds_read_b128 a[120:123], v6 offset:6144
    ds_read_b128 a[124:127], v7 offset:6144
    v_fma_f32 v81, -v80, v80, v81
    v_max_f32 v81, 0, v81
    v_cvt_pk_bf16_f32 v82, v80, v81
    v_mfma_f32_16x16x32_bf16 v[72:75], a[4:7], a[76:79], v[72:75]
    ds_read_b128 a[128:131], v6 offset:7168
    ds_read_b128 a[132:135], v7 offset:7168
    v_lshlrev_b32 v80, 16, v82
    v_and_b32 v81, 0xffff0000, v82
    v_add_f32 v81, 0x3727c5ac, v81
    v_mfma_f32_16x16x32_bf16 v[72:75], a[8:11], a[80:83], v[72:75]
    ds_read_b128 a[136:139], v6 offset:8192
    ds_read_b128 a[140:143], v7 offset:8192
    v_cvt_pk_bf16_f32 v82, v81, v81
    v_lshlrev_b32 v81, 16, v82
    v_sqrt_f32 v81, v81
    s_waitcnt lgkmcnt(12)
    v_mfma_f32_16x16x32_bf16 v[72:75], a[12:15], a[84:87], v[72:75]
    ds_write_b8 v11, v12 offset:144
    s_and_b32 s49, s32, 3
    s_lshl_b32 s49, s49, 8
    v_add_u32 v19, s49, v13
    ds_read_b128 v[20:23], v19
    v_cvt_pk_bf16_f32 v82, v81, v81
    v_lshlrev_b32 v81, 16, v82
    v_rcp_f32 v81, v81
    v_mfma_f32_16x16x32_bf16 v[72:75], a[16:19], a[88:91], v[72:75]
    ds_read_b32 v18, v10 offset:304
    v_xor_b32 v80, 0x80000000, v80
    v_mov_b32 v82, s33
    ds_write_b128 v9, v[80:83]
    v_mfma_f32_16x16x32_bf16 v[72:75], a[20:23], a[92:95], v[72:75]
    s_waitcnt vmcnt(1)
    s_mov_b64 exec, s[92:93]
    ds_write_b32 v84, v87 offset:64
    s_mov_b64 exec, -1
    s_add_u32 s37, s37, s90
    s_waitcnt lgkmcnt(14)
    v_mfma_f32_16x16x32_bf16 v[72:75], a[24:27], a[96:99], v[72:75]
    v_mfma_f32_16x16x32_bf16 v[72:75], a[28:31], a[100:103], v[72:75]
    v_mfma_f32_16x16x32_bf16 v[72:75], a[32:35], a[104:107], v[72:75]
    s_waitcnt lgkmcnt(11)
    v_mfma_f32_16x16x32_bf16 v[72:75], a[36:39], a[108:111], v[72:75]
    v_mfma_f32_16x16x32_bf16 v[72:75], a[40:43], a[112:115], v[72:75]
    v_mfma_f32_16x16x32_bf16 v[72:75], a[44:47], a[116:119], v[72:75]
    s_waitcnt lgkmcnt(8)
    v_mfma_f32_16x16x32_bf16 v[72:75], a[48:51], a[120:123], v[72:75]
    v_mfma_f32_16x16x32_bf16 v[72:75], a[52:55], a[124:127], v[72:75]
    v_mfma_f32_16x16x32_bf16 v[72:75], a[56:59], a[128:131], v[72:75]
    s_waitcnt lgkmcnt(5)
    v_mfma_f32_16x16x32_bf16 v[72:75], a[60:63], a[132:135], v[72:75]
    v_mfma_f32_16x16x32_bf16 v[72:75], a[64:67], a[136:139], v[72:75]
    v_mfma_f32_16x16x32_bf16 v[72:75], a[68:71], a[140:143], v[72:75]
    s_waitcnt lgkmcnt(2)
    v_readfirstlane_b32 s40, v18
    s_nop 0
    s_cmp_ge_u32 s40, 2
    s_cbranch_scc1 L_mfr150
L_fr151:
    ds_read_b32 v18, v10 offset:304
    s_waitcnt lgkmcnt(0)
    v_readfirstlane_b32 s40, v18
    s_nop 0
    s_cmp_ge_u32 s40, 2
    s_cbranch_scc1 L_frx152
    s_cmp_eq_u32 s28, 0
    s_cbranch_scc1 L_frx152
    s_sub_u32 s28, s28, 1
    s_branch L_fr151
L_frx152:
L_mfr150:
    s_nop 2
    ds_read_b32 v100, v8 offset:144
    v_fma_f32 v64, v24, v20, v72
    v_fma_f32 v65, v25, v20, v73
    v_fma_f32 v66, v26, v20, v74
    v_fma_f32 v67, v27, v20, v75
    v_mul_f32 v64, v64, v21
    v_mul_f32 v65, v65, v21
    v_mul_f32 v66, v66, v21
    v_mul_f32 v67, v67, v21
    v_cvt_pk_bf16_f32 v64, v64, v65
    v_cvt_pk_bf16_f32 v65, v66, v67
    v_add_u32 v16, v14, v22
    ds_write_b64 v16, v[64:65]
    ds_write_b8 v11, v12 offset:224
    v_add_u32 v10, 4, v10
    v_add_u32 v11, 4, v11
    s_add_u32 s32, s32, 1
    s_waitcnt vmcnt(0) lgkmcnt(2)
    v_cmp_eq_u32 s[44:45], s94, v108
    s_branch L5_m2
L5_m_idle:
    s_cmp_lt_u32 s37, s36
    s_cbranch_scc0 L5_m_id2
    s_waitcnt vmcnt(18)
    v_add_f32 v80, v104, v106
    v_add_f32 v81, v105, v107
    buffer_load_dword v108, v109, s[4:7], s52 offen sc1
    v_readlane_b32 s33, v86, s37
    v_add_f32_dpp v80, v80, v80 quad_perm:[1,0,3,2] row_mask:0xf bank_mask:0xf
    v_add_f32_dpp v81, v81, v81 quad_perm:[1,0,3,2] row_mask:0xf bank_mask:0xf
    s_and_b32 s48, s37, 3
    s_cmp_lt_u32 s37, s36
    s_cselect_b32 s90, 1, 0
    s_cselect_b32 s48, s48, 4
    s_cselect_b32 s47, s37, 17
    v_add_f32_dpp v80, v80, v80 quad_perm:[2,3,0,1] row_mask:0xf bank_mask:0xf
    v_add_f32_dpp v81, v81, v81 quad_perm:[2,3,0,1] row_mask:0xf bank_mask:0xf
    s_lshl_b32 s48, s48, 8
    s_lshl_b64 s[92:93], 1, s47
    v_add_u32 v9, s48, v17
    v_mul_f32 v80, 0x3ae38e39, v80
    v_mul_f32 v81, 0x3ae38e39, v81
    v_fma_f32 v81, -v80, v80, v81
    v_max_f32 v81, 0, v81
    v_cvt_pk_bf16_f32 v82, v80, v81
    v_lshlrev_b32 v80, 16, v82
    v_and_b32 v81, 0xffff0000, v82
    v_add_f32 v81, 0x3727c5ac, v81
    v_cvt_pk_bf16_f32 v82, v81, v81
    v_lshlrev_b32 v81, 16, v82
    v_sqrt_f32 v81, v81
    s_nop 0
    v_cvt_pk_bf16_f32 v82, v81, v81
    v_lshlrev_b32 v81, 16, v82
    v_rcp_f32 v81, v81
    v_xor_b32 v80, 0x80000000, v80
    v_mov_b32 v82, s33
    ds_write_b128 v9, v[80:83]
    s_waitcnt vmcnt(1)
    s_mov_b64 exec, s[92:93]
    ds_write_b32 v84, v87 offset:64
    s_mov_b64 exec, -1
    s_add_u32 s37, s37, s90
    ds_read_b32 v100, v8 offset:144
    s_waitcnt vmcnt(0) lgkmcnt(0)
    v_cmp_eq_u32 s[44:45], s94, v108
    s_branch L5_m2
L5_m_id2:
    s_cmp_ge_u32 s36, 16
    s_cbranch_scc1 L5_fin
    s_cmp_lt_u32 s36, 8
    s_cbranch_scc1 L5_m_np
    s_cmp_lt_u32 s36, 16
    s_cbranch_scc1 L5_m_id4
    ds_read_b32 v18, v84 offset:64
    s_waitcnt lgkmcnt(0)
    v_readlane_b32 s40, v18, s36
    s_nop 0
    s_cmp_eq_u32 s40, 0
    s_cbranch_scc1 L5_m_np
    s_add_u32 s36, s36, 1
    s_mov_b32 s37, s36
    s_branch L5_m_nf
L5_m_id4:
    buffer_load_dword v108, v109, s[4:7], s52 offen sc1
    s_waitcnt vmcnt(0)
    v_cmp_eq_u32 s[44:45], s94, v108
L5_m_np:
    s_cmp_eq_u32 s28, 0
    s_cbranch_scc1 L5_fin
    s_sub_u32 s28, s28, 1
    s_branch L5_m
L5_fin:
L5_end:
L5_codeend:
    s_endpgm
.section .rodata,"a"
.p2align 6
.amdhsa_kernel interleave_layers__sliding_local_dilated__ssm_conv_h3__prompt_kernel
  .amdhsa_next_free_vgpr 256
  .amdhsa_next_free_sgpr 102
  .amdhsa_accum_offset 112
  .amdhsa_group_segment_fixed_size 0
  .amdhsa_kernarg_size 96
  .amdhsa_user_sgpr_count 2
  .amdhsa_user_sgpr_kernarg_segment_ptr 1
  .amdhsa_system_sgpr_workgroup_id_x 1
.end_amdhsa_kernel
```
